```python
import torch

def _softmax(x, axis=-1):
    return torch.softmax(x, dim=axis)
def _gelu(x):
    return torch.nn.functional.gelu(x, approximate="tanh")
def _silu(x):
    return torch.nn.functional.silu(x)
def _sigmoid(x):
    return torch.sigmoid(x)
def _layernorm(x, axis=-1, eps=1e-5):
    m = x.mean(dim=axis, keepdim=True)
    v = x.var(dim=axis, keepdim=True, unbiased=False)
    return (x - m) / torch.sqrt(v + eps)
def _scatter_add(tgt, idx, src, axis=0):
    return tgt.clone().index_add_(axis, idx, src)
def _segment_sum(src, seg, n):
    out = torch.zeros((n,) + src.shape[1:], dtype=src.dtype)
    return out.index_add_(0, seg, src)
def _pad(x, pw):
    flat = tuple(v for pair in reversed(pw) for v in pair)
    return torch.nn.functional.pad(x, flat)

kernel_name = 'sequential_preLN__mha_block_cached__swiglu_ffn__decode'

def setup_inputs():

    _w = (lambda a: (lambda t: t.to(torch.bfloat16) if t.is_floating_point() else t)(torch.as_tensor(a)))
    def _A_setup():
        B, Sq, D = 1, 1, 512
        H, Sk, Dh = 32, 16384, 128
        return {
            "x": _w((lambda *s: torch.randn(*s, dtype=torch.bfloat16) * 0.05)(B, Sq, D)),
            "k_cache": _w((lambda *s: torch.randn(*s, dtype=torch.bfloat16) * 3.2)(B, H, Sk, Dh)),
            "v_cache": _w((lambda *s: torch.randn(*s, dtype=torch.bfloat16) * 0.4)(B, H, Sk, Dh)),
            "wq": _w((lambda *s: torch.randn(*s, dtype=torch.bfloat16) * 3.2)(D, H * Dh) * (D ** -0.5)),
            "wo": _w((lambda *s: torch.randn(*s, dtype=torch.bfloat16) * 0.4)(H * Dh, D) * ((H * Dh) ** -0.5)),
        }
    _A_in = _A_setup()

    def _B_setup():
        B, S, D, F = 1, 1, 512, 1792
        return {
            "x": _w((lambda *s: torch.randn(*s, dtype=torch.bfloat16) * 0.05)(B, S, D)),
            "w_gate": _w((lambda *s: torch.randn(*s, dtype=torch.bfloat16) * 0.05)(D, F)),
            "w_up": _w((lambda *s: torch.randn(*s, dtype=torch.bfloat16) * 0.05)(D, F)),
            "w_down": _w((lambda *s: torch.randn(*s, dtype=torch.bfloat16) * 0.05)(F, D)),
        }
    _B_in = _B_setup()

    return {
        "A_x": _A_in["x"],
        "A_k_cache": _A_in["k_cache"],
        "A_v_cache": _A_in["v_cache"],
        "A_wq": _A_in["wq"],
        "A_wo": _A_in["wo"],
        "B_x": _B_in["x"],
        "B_w_gate": _B_in["w_gate"],
        "B_w_up": _B_in["w_up"],
        "B_w_down": _B_in["w_down"],
    }

def reference(A_x, A_k_cache, A_v_cache, A_wq, A_wo, B_x, B_w_gate, B_w_up, B_w_down):
    def _A_ref(x, k_cache, v_cache, wq, wo):
        B, Sq, D = x.shape
        H, Dh = 32, 128
        q = (lambda x, *d: x.permute(*d))((x @ wq).reshape(B, Sq, H, Dh), 0, 2, 1, 3)
        scores = torch.einsum("bhqd,bhkd->bhqk", q, k_cache) * (Dh ** -0.5)
        p = _softmax(scores, axis=-1)
        o = torch.einsum("bhqk,bhkd->bhqd", p, v_cache)
        return (lambda x, *d: x.permute(*d))(o, 0, 2, 1, 3).reshape(B, Sq, H * Dh) @ wo

    def _B_ref(x, w_gate, w_up, w_down):
        g = _silu(x @ w_gate)
        u = x @ w_up
        return (g * u) @ w_down

    x = A_x
    h = x + _A_ref(_layernorm(x, axis=-1), A_k_cache, A_v_cache, A_wq, A_wo)
    h2 = h + _B_ref(_layernorm(h, axis=-1), B_w_gate, B_w_up, B_w_down)
    return h2
```

```asm
; @launch grid=(256,1,1) block=(320,1,1) lds=86016
.amdgcn_target "amdgcn-amd-amdhsa--gfx950"
.text
.globl sequential_preLN__mha_block_cached__swiglu_ffn__decode_kernel
.p2align 8
.type sequential_preLN__mha_block_cached__swiglu_ffn__decode_kernel,@function
sequential_preLN__mha_block_cached__swiglu_ffn__decode_kernel:
    s_cmp_ge_u32 s2, 256
    s_cbranch_scc1 L_done
    s_load_dwordx8 s[4:11], s[0:1], 0
    s_load_dwordx2 s[26:27], s[0:1], 88
    s_load_dwordx2 s[12:13], s[0:1], 32
    s_load_dwordx8 s[16:23], s[0:1], 48
    v_lshrrev_b32 v3, 6, v0
    v_and_b32 v1, 63, v0
    v_readfirstlane_b32 s39, v3
    v_lshlrev_b32 v2, 4, v1
    s_and_b32 s3, s2, 7
    s_lshl_b32 s3, s3, 2
    s_bfe_u32 s14, s2, 0x20003
    s_or_b32 s37, s3, s14
    s_lshr_b32 s38, s2, 5
    s_cmp_eq_u32 s39, 4
    s_cbranch_scc1 L_svc
    s_and_b32 s43, s37, 15
    s_lshl_b32 s43, s43, 18
    s_lshl_b32 s3, s38, 3
    s_add_u32 s3, s3, s39
    s_lshl_b32 s3, s3, 12
    v_add_u32 v0, 0x4000, v2
    s_or_b32 s43, s43, s3
    s_lshl_b32 s14, s37, 22
    s_mov_b32 s30, 4194304
    s_mov_b32 s31, 0x20000
    s_waitcnt lgkmcnt(0)
    s_add_u32 s28, s6, s14
    s_addc_u32 s29, s7, 0
    buffer_load_dwordx4 v[64:67], v2, s[28:31], s43 offen offset:0 nt
    buffer_load_dwordx4 v[68:71], v2, s[28:31], s43 offen offset:1024 nt
    buffer_load_dwordx4 v[72:75], v2, s[28:31], s43 offen offset:2048 nt
    buffer_load_dwordx4 v[76:79], v2, s[28:31], s43 offen offset:3072 nt
    buffer_load_dwordx4 v[80:83], v0, s[28:31], s43 offen offset:0 nt
    s_xor_b32 s40, s43, 262144
    s_xor_b32 s41, s43, 524288
    s_xor_b32 s42, s43, 786432
    s_xor_b32 s96, s43, 1048576
    s_load_dword s54, s[26:27], 0
    s_add_u32 s32, s8, s14
    s_addc_u32 s33, s9, 0
    s_mov_b32 s34, 4194304
    s_mov_b32 s35, 0x20000
    s_mov_b32 s98, 4194304
    s_mov_b32 s99, 0x20000
    s_and_b32 s55, s2, 7
    s_lshr_b32 s53, s2, 3
    s_and_b32 s49, s53, 15
    s_mov_b32 s48, 200000
    s_or_b32 s3, s53, s39
    s_cbranch_scc1 L_nocw0
    s_getpc_b64 s[0:1]
L_pc0:
    v_lshlrev_b32 v22, 7, v1
    v_add_u32 v23, 0x2000, v22
    v_min_u32 v23, L_codeend-L_pc0-4, v23
    global_load_dword v246, v22, s[0:1]
    global_load_dword v246, v23, s[0:1]
L_nocw0:
    v_and_b32 v22, 1, v1
    v_lshlrev_b32 v22, 4, v22
    v_mov_b32 v23, 0xffff
    v_lshlrev_b32 v22, v22, v23
    v_bfe_u32 v23, v1, 1, 2
    v_cmp_eq_u32 vcc, 0, v23
    s_nop 1
    v_cndmask_b32 v4, 0, v22, vcc
    v_cmp_eq_u32 vcc, 1, v23
    s_nop 1
    v_cndmask_b32 v5, 0, v22, vcc
    v_cmp_eq_u32 vcc, 2, v23
    s_nop 1
    v_cndmask_b32 v6, 0, v22, vcc
    v_cmp_eq_u32 vcc, 3, v23
    s_nop 1
    v_cndmask_b32 v7, 0, v22, vcc
    v_mov_b32 v12, 0
    v_mov_b32 v13, 0
    v_mov_b32 v14, 0
    v_mov_b32 v15, 0
    v_mov_b32 v16, 0
    v_mov_b32 v17, 0xff800000
    v_mov_b32 v3, 0
    v_mov_b32 v250, 0
    v_mov_b32 v251, 0
    v_lshrrev_b32 v18, 3, v1
    v_and_b32 v19, 7, v1
    v_lshrrev_b32 v20, 4, v1
    v_and_b32 v21, 15, v1
    v_lshlrev_b32 v42, 4, v21
    s_lshl_b32 s3, s39, 12
    v_lshl_add_u32 v41, v1, 2, s3
    v_and_b32 v22, 1, v20
    v_lshlrev_b32 v36, 5, v21
    v_lshl_add_u32 v36, v22, 4, v36
    s_mul_i32 s3, s39, 528
    v_add_u32 v36, s3, v36
    s_lshl_b32 s3, s39, 3
    v_mov_b32 v37, s3
    v_and_b32 v22, 3, v1
    v_mul_u32_u24 v38, 528, v22
    v_lshrrev_b32 v23, 2, v1
    v_lshl_add_u32 v38, v23, 3, v38
    s_lshl_b32 s3, s39, 7
    v_add_u32 v38, s3, v38
    v_lshlrev_b32 v39, 3, v22
    s_mul_i32 s3, s37, 4224
    s_lshl_b32 s14, s39, 10
    s_add_u32 s3, s3, s14
    s_lshl_b32 s14, s38, 4
    s_add_u32 s3, s3, s14
    s_add_u32 s3, s3, 327680
    v_lshlrev_b32 v40, 7, v18
    v_lshl_add_u32 v40, v22, 12, v40
    v_and_b32 v24, 1, v23
    v_lshl_add_u32 v40, v24, 3, v40
    v_add_u32 v40, s3, v40
    s_cmp_eq_u32 s39, 0
    s_mov_b32 s51, 0x11111111
    s_cselect_b32 s50, 0x11111133, s51
    v_cmp_eq_u32 s[56:57], 1, v1
    v_cmp_eq_u32 s[58:59], 5, v1
    s_lshl_b32 s3, s55, 11
    s_add_u32 s3, s3, 589824
    s_add_u32 s60, s26, s3
    s_addc_u32 s61, s27, 0
    s_lshl_b32 s15, s49, 1
    s_and_b32 s14, s39, 1
    s_add_u32 s15, s15, s14
    s_lshl_b32 s3, s15, 10
    s_add_u32 s3, s3, 524288
    s_add_u32 s10, s26, s3
    s_addc_u32 s11, s27, 0
    v_lshlrev_b32 v252, 3, v21
    v_add_u32 v252, 622592, v252
    s_lshr_b32 s3, s53, 4
    s_lshl_b32 s14, s55, 1
    s_add_u32 s3, s3, s14
    s_lshl_b32 s3, s3, 3
    s_add_u32 s3, s3, 622592
    v_mov_b32 v253, s3
    s_add_u32 s3, s53, s55
    s_and_b32 s3, s3, 15
    s_or_b32 s3, s3, s39
    s_cselect_b64 s[44:45], 0, 1
    s_mov_b64 s[62:63], 0
    s_cmp_ge_u32 s53, 16
    s_cbranch_scc1 L_setB
    s_lshl_b32 s3, s55, 2
    s_add_u32 s3, s3, s39
    s_mul_i32 s3, s3, 4224
    s_add_u32 s3, s3, 327680
    s_add_u32 s6, s26, s3
    s_addc_u32 s7, s27, 0
    v_lshl_add_u32 v43, v20, 2, v21
    v_and_b32 v43, 7, v43
    v_lshlrev_b32 v43, 4, v43
    v_add_u32 v43, 4096, v43
    v_mul_u32_u24 v44, 80, v21
    v_lshl_add_u32 v44, v20, 2, v44
    s_lshl_b32 s3, s39, 4
    v_add_u32 v44, s3, v44
    s_and_b32 s14, s39, 1
    v_mul_u32_u24 v45, 80, v23
    v_lshl_add_u32 v45, v22, 4, v45
    s_mul_i32 s3, s14, 1280
    v_add_u32 v45, s3, v45
    s_lshl_b32 s3, s49, 3
    s_add_u32 s3, s3, s55
    s_lshl_b32 s3, s3, 1
    s_add_u32 s3, s3, s14
    s_lshl_b32 s3, s3, 7
    s_add_u32 s3, s3, 491520
    v_lshl_add_u32 v46, v23, 3, s3
    v_bfe_u32 v24, v1, 2, 1
    v_lshlrev_b32 v47, 9, v20
    v_lshl_add_u32 v47, v24, 6, v47
    v_lshl_add_u32 v47, v22, 3, v47
    v_bfe_u32 v24, v1, 3, 1
    v_lshl_add_u32 v47, v24, 11, v47
    s_lshl_b32 s3, s39, 13
    s_add_u32 s3, s3, 21504
    v_add_u32 v47, s3, v47
    v_min_u32 v24, 13, v21
    v_mad_u32_u24 v24, v20, 14, v24
    v_lshlrev_b32 v56, 4, v24
    v_mul_u32_u24 v57, 1792, v20
    v_lshl_add_u32 v57, v21, 3, v57
    s_mul_i32 s3, s14, 7168
    s_add_u32 s3, s3, 56320
    v_add_u32 v57, s3, v57
    v_lshrrev_b32 v24, 1, v1
    v_lshlrev_b32 v24, 10, v24
    v_and_b32 v25, 1, v1
    v_lshl_add_u32 v24, v25, 4, v24
    s_mul_i32 s3, s55, 229376
    s_lshl_b32 s14, s15, 5
    s_add_u32 s3, s3, s14
    s_add_u32 s3, s3, 3072
    v_add_u32 v58, s3, v24
    s_lshl_b32 s3, s55, 7
    v_lshl_add_u32 v59, v1, 3, s3
    s_nop 0
    s_branch L_setE
L_setB:
    s_lshl_b32 s3, s39, 3
    v_add_u32 v24, s3, v19
    v_lshlrev_b32 v44, 1, v24
    s_lshl_b32 s3, s49, 6
    s_add_u32 s4, s4, s3
    s_addc_u32 s5, s5, 0
    global_load_ushort v60, v44, s[4:5]
    s_lshl_b32 s3, s15, 5
    s_add_u32 s22, s22, s3
    s_addc_u32 s23, s23, 0
    s_lshl_b32 s3, s49, 11
    s_add_u32 s3, s3, 491520
    v_lshlrev_b32 v43, 8, v18
    v_lshl_add_u32 v43, v24, 3, v43
    v_add_u32 v43, s3, v43
    v_lshlrev_b32 v61, 4, v20
    s_mul_i32 s3, s55, 16896
    s_add_u32 s3, s3, 331776
    v_mul_u32_u24 v62, 4224, v20
    v_lshl_add_u32 v62, v19, 4, v62
    v_add_u32 v62, s3, v62
    v_bfe_u32 v24, v1, 2, 3
    v_lshrrev_b32 v25, 5, v1
    v_lshl_add_u32 v24, v25, 4, v24
    v_mul_u32_u24 v45, 1056, v24
    v_lshl_add_u32 v45, v22, 3, v45
    s_lshl_b32 s3, s39, 7
    s_add_u32 s3, s3, 21504
    v_add_u32 v45, s3, v45
    s_lshr_b32 s3, s39, 1
    s_lshl_b32 s3, s3, 2
    s_and_b32 s14, s39, 1
    s_add_u32 s3, s3, s14
    s_lshl_b32 s14, s49, 3
    s_add_u32 s3, s3, s14
    s_mul_i32 s3, s3, 14336
    s_mul_i32 s14, s55, 448
    s_add_u32 s3, s3, s14
    v_and_b32 v24, 31, v1
    v_lshl_add_u32 v24, v24, 4, s3
    v_mov_b32 v56, s16
    v_mov_b32 v57, s17
    s_mov_b32 exec_lo, 0
    v_mov_b32 v56, s18
    v_mov_b32 v57, s19
    s_mov_b32 exec_lo, -1
    v_add_co_u32 v56, vcc, v56, v24
    s_nop 1
    v_addc_co_u32 v57, vcc, 0, v57, vcc
    s_lshl_b32 s3, s39, 2
    v_add_u32 v24, s3, v20
    s_mul_i32 s3, s55, 59136
    s_lshl_b32 s14, s49, 8
    s_add_u32 s3, s3, s14
    s_add_u32 s3, s3, 655360
    v_mul_u32_u24 v46, 4224, v24
    v_add3_u32 v46, v46, v42, s3
    s_lshl_b32 s3, s55, 11
    s_lshl_b32 s14, s49, 4
    s_add_u32 s3, s3, s14
    s_add_u32 s3, s3, 589824
    v_mov_b32 v25, s3
    v_add_u32 v26, 512, v25
    v_cmp_le_u32 vcc, 14, v24
    s_nop 1
    v_cndmask_b32 v46, v46, v26, vcc
    v_cmp_eq_u32 s[12:13], 14, v24
    s_nop 1
    v_cndmask_b32 v46, v46, v25, s[12:13]
    s_mul_i32 s3, s55, 14
    s_add_u32 s3, s3, s49
    s_mul_i32 s3, s3, 4224
    s_add_u32 s3, s3, 655360
    s_add_u32 s8, s26, s3
    s_addc_u32 s9, s27, 0
    s_lshl_b32 s3, s49, 6
    v_lshl_add_u32 v47, v1, 2, s3
    v_lshlrev_b32 v58, 7, v20
    v_lshl_add_u32 v58, v21, 3, v58
    v_lshlrev_b32 v59, 1, v21
    v_and_b32 v24, 1, v1
    v_cmp_eq_u32 vcc, 0, v24
    s_nop 1
    v_cndmask_b32 v248, 0, -1, vcc
    v_mov_b32 v25, 0x3f803f80
    v_cndmask_b32 v249, v25, 0, vcc
    v_cndmask_b32 v248, 64, v61, vcc
    v_lshlrev_b32 v24, 2, v22
    ds_write_b32 v24, v25 offset:5040
    s_cmp_eq_u32 s39, 3
    s_cselect_b64 s[24:25], -1, 0
    s_and_b32 s3, s49, 7
    s_xor_b32 s3, s3, s55
    s_lshr_b32 s14, s39, 1
    s_xor_b32 s14, s14, 1
    s_or_b32 s3, s3, s14
    s_cselect_b64 s[62:63], 0, -1
L_setE:
    s_waitcnt lgkmcnt(0)
    s_mul_i32 s54, s54, 1664525
    s_add_u32 s54, s54, 1013904223
    s_or_b32 s36, s54, 0x20000000
    v_mov_b32 v49, s36
    v_mov_b32 v51, s36
    s_waitcnt vmcnt(4)
    buffer_load_dwordx4 v[84:87], v0, s[28:31], s43 offen offset:1024 nt
    s_waitcnt vmcnt(4)
    buffer_load_dwordx4 v[88:91], v0, s[28:31], s43 offen offset:2048 nt
    s_waitcnt vmcnt(4)
    buffer_load_dwordx4 v[92:95], v0, s[28:31], s43 offen offset:3072 nt
    s_waitcnt vmcnt(4)
    buffer_load_dwordx4 v[96:99], v2, s[28:31], s40 offen offset:0 nt
    s_waitcnt vmcnt(4)
    buffer_load_dwordx4 v[100:103], v2, s[28:31], s40 offen offset:1024 nt
    s_waitcnt vmcnt(4)
    buffer_load_dwordx4 v[104:107], v2, s[28:31], s40 offen offset:2048 nt
    s_waitcnt vmcnt(4)
    buffer_load_dwordx4 v[108:111], v2, s[28:31], s40 offen offset:3072 nt
    s_waitcnt vmcnt(4)
    buffer_load_dwordx4 v[112:115], v0, s[28:31], s40 offen offset:0 nt
    s_waitcnt vmcnt(4)
    buffer_load_dwordx4 v[116:119], v0, s[28:31], s40 offen offset:1024 nt
    s_waitcnt vmcnt(4)
    buffer_load_dwordx4 v[120:123], v0, s[28:31], s40 offen offset:2048 nt
    s_waitcnt vmcnt(4)
    buffer_load_dwordx4 v[124:127], v0, s[28:31], s40 offen offset:3072 nt
    s_waitcnt vmcnt(4)
    buffer_load_dwordx4 v[128:131], v2, s[28:31], s41 offen offset:0 nt
    s_waitcnt vmcnt(4)
    buffer_load_dwordx4 v[132:135], v2, s[28:31], s41 offen offset:1024 nt
    s_waitcnt vmcnt(4)
    buffer_load_dwordx4 v[136:139], v2, s[28:31], s41 offen offset:2048 nt
    s_waitcnt vmcnt(4)
    buffer_load_dwordx4 v[140:143], v2, s[28:31], s41 offen offset:3072 nt
    s_waitcnt vmcnt(4)
    buffer_load_dwordx4 v[144:147], v0, s[28:31], s41 offen offset:0 nt
    s_waitcnt vmcnt(4)
    buffer_load_dwordx4 v[148:151], v0, s[28:31], s41 offen offset:1024 nt
    s_waitcnt vmcnt(4)
    buffer_load_dwordx4 v[152:155], v0, s[28:31], s41 offen offset:2048 nt
    s_waitcnt vmcnt(4)
    buffer_load_dwordx4 v[156:159], v0, s[28:31], s41 offen offset:3072 nt
    s_waitcnt vmcnt(4)
    buffer_load_dwordx4 v[160:163], v2, s[28:31], s42 offen offset:0 nt
    s_waitcnt vmcnt(4)
    buffer_load_dwordx4 v[164:167], v2, s[28:31], s42 offen offset:1024 nt
    s_waitcnt vmcnt(4)
    buffer_load_dwordx4 v[168:171], v2, s[28:31], s42 offen offset:2048 nt
    s_waitcnt vmcnt(4)
    buffer_load_dwordx4 v[172:175], v2, s[28:31], s42 offen offset:3072 nt
    s_waitcnt vmcnt(4)
    buffer_load_dwordx4 v[176:179], v0, s[28:31], s42 offen offset:0 nt
    s_waitcnt vmcnt(4)
    buffer_load_dwordx4 v[180:183], v0, s[28:31], s42 offen offset:1024 nt
    s_waitcnt vmcnt(4)
    buffer_load_dwordx4 v[184:187], v0, s[28:31], s42 offen offset:2048 nt
    s_waitcnt vmcnt(4)
    buffer_load_dwordx4 v[188:191], v0, s[28:31], s42 offen offset:3072 nt
    s_waitcnt vmcnt(4)
    buffer_load_dwordx4 v[192:195], v2, s[28:31], s96 offen offset:0 nt
    s_waitcnt vmcnt(4)
    buffer_load_dwordx4 v[196:199], v2, s[28:31], s96 offen offset:1024 nt
    s_waitcnt vmcnt(4)
    buffer_load_dwordx4 v[200:203], v2, s[28:31], s96 offen offset:2048 nt
    s_waitcnt vmcnt(4)
    buffer_load_dwordx4 v[204:207], v2, s[28:31], s96 offen offset:3072 nt
    s_waitcnt vmcnt(4)
    buffer_load_dwordx4 v[208:211], v0, s[28:31], s96 offen offset:0 nt
    s_waitcnt vmcnt(4)
    buffer_load_dwordx4 v[212:215], v0, s[28:31], s96 offen offset:1024 nt
    s_waitcnt vmcnt(4)
    buffer_load_dwordx4 v[216:219], v0, s[28:31], s96 offen offset:2048 nt
    s_waitcnt vmcnt(4)
    buffer_load_dwordx4 v[220:223], v0, s[28:31], s96 offen offset:3072 nt
    s_barrier
    ds_read_b128 v[8:11], v42 offset:0
    ds_read_b32 v22, v3 offset:2400
    s_memrealtime s[4:5]
    s_xor_b32 s41, s43, 1310720
    s_xor_b32 s40, s43, 1572864
    s_waitcnt lgkmcnt(0)
    v_readfirstlane_b32 s52, v22
    s_add_u32 s4, s4, 4294967280
    v_mov_b32 v50, s4
    s_mov_b64 exec, s[44:45]
    s_nop 0
    s_cbranch_execz L_np0
    global_store_dwordx2 v253, v[50:51], s[26:27] sc1
L_np0:
    s_mov_b64 exec, -1
    v_add_u32 v253, 128, v253
    s_waitcnt vmcnt(39)
    v_dot2_f32_bf16 v18, v64, v8, 0
    v_dot2_f32_bf16 v18, v65, v9, v18
    v_dot2_f32_bf16 v18, v66, v10, v18
    v_dot2_f32_bf16 v18, v67, v11, v18
    s_waitcnt vmcnt(4)
    buffer_load_dwordx4 v[64:67], v2, s[28:31], s41 offen offset:0 nt
    s_waitcnt vmcnt(39)
    v_dot2_f32_bf16 v19, v68, v8, 0
    v_dot2_f32_bf16 v19, v69, v9, v19
    v_dot2_f32_bf16 v19, v70, v10, v19
    v_dot2_f32_bf16 v19, v71, v11, v19
    s_waitcnt vmcnt(38)
    v_dot2_f32_bf16 v20, v72, v8, 0
    v_dot2_f32_bf16 v20, v73, v9, v20
    v_dot2_f32_bf16 v20, v74, v10, v20
    v_dot2_f32_bf16 v20, v75, v11, v20
    s_waitcnt vmcnt(37)
    v_dot2_f32_bf16 v21, v76, v8, 0
    v_dot2_f32_bf16 v21, v77, v9, v21
    v_dot2_f32_bf16 v21, v78, v10, v21
    v_dot2_f32_bf16 v21, v79, v11, v21
    s_waitcnt vmcnt(4)
    buffer_load_dwordx4 v[68:71], v2, s[28:31], s41 offen offset:1024 nt
    v_add_f32_dpp v22, v18, v18 row_ror:8 row_mask:0xf bank_mask:0xf
    v_add_f32_dpp v23, v20, v20 row_ror:8 row_mask:0xf bank_mask:0xf
    v_add_f32_dpp v22, v19, v19 row_ror:8 row_mask:0xf bank_mask:0xc
    v_add_f32_dpp v23, v21, v21 row_ror:8 row_mask:0xf bank_mask:0xc
    s_nop 0
    v_add_f32_dpp v24, v22, v22 row_shl:4 row_mask:0xf bank_mask:0x5
    v_add_f32_dpp v24, v23, v23 row_shr:4 row_mask:0xf bank_mask:0xa
    s_nop 1
    v_add_f32_dpp v24, v24, v24 quad_perm:[1,0,3,2] row_mask:0xf bank_mask:0xf
    s_nop 1
    v_add_f32_dpp v24, v24, v24 quad_perm:[2,3,0,1] row_mask:0xf bank_mask:0xf
    s_waitcnt vmcnt(37)
    v_dot2_f32_bf16 v18, v80, v8, 0
    v_dot2_f32_bf16 v18, v81, v9, v18
    v_dot2_f32_bf16 v18, v82, v10, v18
    v_dot2_f32_bf16 v18, v83, v11, v18
    s_waitcnt vmcnt(36)
    v_dot2_f32_bf16 v19, v84, v8, 0
    v_dot2_f32_bf16 v19, v85, v9, v19
    v_dot2_f32_bf16 v19, v86, v10, v19
    v_dot2_f32_bf16 v19, v87, v11, v19
    s_waitcnt vmcnt(35)
    v_dot2_f32_bf16 v20, v88, v8, 0
    v_dot2_f32_bf16 v20, v89, v9, v20
    v_dot2_f32_bf16 v20, v90, v10, v20
    v_dot2_f32_bf16 v20, v91, v11, v20
    s_waitcnt vmcnt(34)
    v_dot2_f32_bf16 v21, v92, v8, 0
    v_dot2_f32_bf16 v21, v93, v9, v21
    v_dot2_f32_bf16 v21, v94, v10, v21
    v_dot2_f32_bf16 v21, v95, v11, v21
    s_waitcnt vmcnt(4)
    buffer_load_dwordx4 v[72:75], v2, s[28:31], s41 offen offset:2048 nt
    v_add_f32_dpp v22, v18, v18 row_ror:8 row_mask:0xf bank_mask:0xf
    v_add_f32_dpp v23, v20, v20 row_ror:8 row_mask:0xf bank_mask:0xf
    v_add_f32_dpp v22, v19, v19 row_ror:8 row_mask:0xf bank_mask:0xc
    v_add_f32_dpp v23, v21, v21 row_ror:8 row_mask:0xf bank_mask:0xc
    s_nop 0
    v_add_f32_dpp v25, v22, v22 row_shl:4 row_mask:0xf bank_mask:0x5
    v_add_f32_dpp v25, v23, v23 row_shr:4 row_mask:0xf bank_mask:0xa
    s_nop 1
    v_add_f32_dpp v25, v25, v25 quad_perm:[1,0,3,2] row_mask:0xf bank_mask:0xf
    s_nop 1
    v_add_f32_dpp v25, v25, v25 quad_perm:[2,3,0,1] row_mask:0xf bank_mask:0xf
    v_cvt_pk_bf16_f32 v24, v24, v25
    v_and_b32 v25, 0xffff0000, v24
    v_lshlrev_b32 v24, 16, v24
    v_mul_f32 v24, 0x3db504f3, v24
    v_mul_f32 v25, 0x3db504f3, v25
    v_cvt_pk_bf16_f32 v26, v24, v25
    ds_write_b32 v41, v26 offset:5120
    v_and_b32 v25, 0xffff0000, v26
    v_lshlrev_b32 v24, 16, v26
    v_max3_f32 v17, v17, v24, v25
    s_waitcnt vmcnt(34)
    v_dot2_f32_bf16 v18, v96, v8, 0
    v_dot2_f32_bf16 v18, v97, v9, v18
    v_dot2_f32_bf16 v18, v98, v10, v18
    v_dot2_f32_bf16 v18, v99, v11, v18
    s_waitcnt vmcnt(33)
    v_dot2_f32_bf16 v19, v100, v8, 0
    v_dot2_f32_bf16 v19, v101, v9, v19
    v_dot2_f32_bf16 v19, v102, v10, v19
    v_dot2_f32_bf16 v19, v103, v11, v19
    s_waitcnt vmcnt(32)
    v_dot2_f32_bf16 v20, v104, v8, 0
    v_dot2_f32_bf16 v20, v105, v9, v20
    v_dot2_f32_bf16 v20, v106, v10, v20
    v_dot2_f32_bf16 v20, v107, v11, v20
    s_waitcnt vmcnt(4)
    buffer_load_dwordx4 v[76:79], v2, s[28:31], s41 offen offset:3072 nt
    s_waitcnt vmcnt(32)
    v_dot2_f32_bf16 v21, v108, v8, 0
    v_dot2_f32_bf16 v21, v109, v9, v21
    v_dot2_f32_bf16 v21, v110, v10, v21
    v_dot2_f32_bf16 v21, v111, v11, v21
    v_add_f32_dpp v22, v18, v18 row_ror:8 row_mask:0xf bank_mask:0xf
    v_add_f32_dpp v23, v20, v20 row_ror:8 row_mask:0xf bank_mask:0xf
    v_add_f32_dpp v22, v19, v19 row_ror:8 row_mask:0xf bank_mask:0xc
    v_add_f32_dpp v23, v21, v21 row_ror:8 row_mask:0xf bank_mask:0xc
    s_nop 0
    v_add_f32_dpp v24, v22, v22 row_shl:4 row_mask:0xf bank_mask:0x5
    v_add_f32_dpp v24, v23, v23 row_shr:4 row_mask:0xf bank_mask:0xa
    s_nop 1
    v_add_f32_dpp v24, v24, v24 quad_perm:[1,0,3,2] row_mask:0xf bank_mask:0xf
    s_nop 1
    v_add_f32_dpp v24, v24, v24 quad_perm:[2,3,0,1] row_mask:0xf bank_mask:0xf
    s_waitcnt vmcnt(31)
    v_dot2_f32_bf16 v18, v112, v8, 0
    v_dot2_f32_bf16 v18, v113, v9, v18
    v_dot2_f32_bf16 v18, v114, v10, v18
    v_dot2_f32_bf16 v18, v115, v11, v18
    s_waitcnt vmcnt(30)
    v_dot2_f32_bf16 v19, v116, v8, 0
    v_dot2_f32_bf16 v19, v117, v9, v19
    v_dot2_f32_bf16 v19, v118, v10, v19
    v_dot2_f32_bf16 v19, v119, v11, v19
    s_waitcnt vmcnt(4)
    buffer_load_dwordx4 v[80:83], v0, s[28:31], s41 offen offset:0 nt
    s_waitcnt vmcnt(30)
    v_dot2_f32_bf16 v20, v120, v8, 0
    v_dot2_f32_bf16 v20, v121, v9, v20
    v_dot2_f32_bf16 v20, v122, v10, v20
    v_dot2_f32_bf16 v20, v123, v11, v20
    s_waitcnt vmcnt(29)
    v_dot2_f32_bf16 v21, v124, v8, 0
    v_dot2_f32_bf16 v21, v125, v9, v21
    v_dot2_f32_bf16 v21, v126, v10, v21
    v_dot2_f32_bf16 v21, v127, v11, v21
    v_add_f32_dpp v22, v18, v18 row_ror:8 row_mask:0xf bank_mask:0xf
    v_add_f32_dpp v23, v20, v20 row_ror:8 row_mask:0xf bank_mask:0xf
    v_add_f32_dpp v22, v19, v19 row_ror:8 row_mask:0xf bank_mask:0xc
    v_add_f32_dpp v23, v21, v21 row_ror:8 row_mask:0xf bank_mask:0xc
    s_nop 0
    v_add_f32_dpp v25, v22, v22 row_shl:4 row_mask:0xf bank_mask:0x5
    v_add_f32_dpp v25, v23, v23 row_shr:4 row_mask:0xf bank_mask:0xa
    s_nop 1
    v_add_f32_dpp v25, v25, v25 quad_perm:[1,0,3,2] row_mask:0xf bank_mask:0xf
    s_nop 1
    v_add_f32_dpp v25, v25, v25 quad_perm:[2,3,0,1] row_mask:0xf bank_mask:0xf
    v_cvt_pk_bf16_f32 v24, v24, v25
    v_and_b32 v25, 0xffff0000, v24
    v_lshlrev_b32 v24, 16, v24
    v_mul_f32 v24, 0x3db504f3, v24
    v_mul_f32 v25, 0x3db504f3, v25
    v_cvt_pk_bf16_f32 v26, v24, v25
    ds_write_b32 v41, v26 offset:5376
    v_and_b32 v25, 0xffff0000, v26
    v_lshlrev_b32 v24, 16, v26
    v_max3_f32 v17, v17, v24, v25
    s_waitcnt vmcnt(28)
    v_dot2_f32_bf16 v18, v128, v8, 0
    v_dot2_f32_bf16 v18, v129, v9, v18
    v_dot2_f32_bf16 v18, v130, v10, v18
    v_dot2_f32_bf16 v18, v131, v11, v18
    s_waitcnt vmcnt(27)
    v_dot2_f32_bf16 v19, v132, v8, 0
    v_dot2_f32_bf16 v19, v133, v9, v19
    v_dot2_f32_bf16 v19, v134, v10, v19
    v_dot2_f32_bf16 v19, v135, v11, v19
    s_waitcnt vmcnt(4)
    buffer_load_dwordx4 v[84:87], v0, s[28:31], s41 offen offset:1024 nt
    s_waitcnt vmcnt(27)
    v_dot2_f32_bf16 v20, v136, v8, 0
    v_dot2_f32_bf16 v20, v137, v9, v20
    v_dot2_f32_bf16 v20, v138, v10, v20
    v_dot2_f32_bf16 v20, v139, v11, v20
    s_waitcnt vmcnt(26)
    v_dot2_f32_bf16 v21, v140, v8, 0
    v_dot2_f32_bf16 v21, v141, v9, v21
    v_dot2_f32_bf16 v21, v142, v10, v21
    v_dot2_f32_bf16 v21, v143, v11, v21
    v_add_f32_dpp v22, v18, v18 row_ror:8 row_mask:0xf bank_mask:0xf
    v_add_f32_dpp v23, v20, v20 row_ror:8 row_mask:0xf bank_mask:0xf
    v_add_f32_dpp v22, v19, v19 row_ror:8 row_mask:0xf bank_mask:0xc
    v_add_f32_dpp v23, v21, v21 row_ror:8 row_mask:0xf bank_mask:0xc
    s_nop 0
    v_add_f32_dpp v24, v22, v22 row_shl:4 row_mask:0xf bank_mask:0x5
    v_add_f32_dpp v24, v23, v23 row_shr:4 row_mask:0xf bank_mask:0xa
    s_nop 1
    v_add_f32_dpp v24, v24, v24 quad_perm:[1,0,3,2] row_mask:0xf bank_mask:0xf
    s_nop 1
    v_add_f32_dpp v24, v24, v24 quad_perm:[2,3,0,1] row_mask:0xf bank_mask:0xf
    s_waitcnt vmcnt(25)
    v_dot2_f32_bf16 v18, v144, v8, 0
    v_dot2_f32_bf16 v18, v145, v9, v18
    v_dot2_f32_bf16 v18, v146, v10, v18
    v_dot2_f32_bf16 v18, v147, v11, v18
    s_waitcnt vmcnt(4)
    buffer_load_dwordx4 v[88:91], v0, s[28:31], s41 offen offset:2048 nt
    s_waitcnt vmcnt(25)
    v_dot2_f32_bf16 v19, v148, v8, 0
    v_dot2_f32_bf16 v19, v149, v9, v19
    v_dot2_f32_bf16 v19, v150, v10, v19
    v_dot2_f32_bf16 v19, v151, v11, v19
    s_waitcnt vmcnt(24)
    v_dot2_f32_bf16 v20, v152, v8, 0
    v_dot2_f32_bf16 v20, v153, v9, v20
    v_dot2_f32_bf16 v20, v154, v10, v20
    v_dot2_f32_bf16 v20, v155, v11, v20
    s_waitcnt vmcnt(23)
    v_dot2_f32_bf16 v21, v156, v8, 0
    v_dot2_f32_bf16 v21, v157, v9, v21
    v_dot2_f32_bf16 v21, v158, v10, v21
    v_dot2_f32_bf16 v21, v159, v11, v21
    v_add_f32_dpp v22, v18, v18 row_ror:8 row_mask:0xf bank_mask:0xf
    v_add_f32_dpp v23, v20, v20 row_ror:8 row_mask:0xf bank_mask:0xf
    v_add_f32_dpp v22, v19, v19 row_ror:8 row_mask:0xf bank_mask:0xc
    v_add_f32_dpp v23, v21, v21 row_ror:8 row_mask:0xf bank_mask:0xc
    s_nop 0
    v_add_f32_dpp v25, v22, v22 row_shl:4 row_mask:0xf bank_mask:0x5
    v_add_f32_dpp v25, v23, v23 row_shr:4 row_mask:0xf bank_mask:0xa
    s_nop 1
    v_add_f32_dpp v25, v25, v25 quad_perm:[1,0,3,2] row_mask:0xf bank_mask:0xf
    s_nop 1
    v_add_f32_dpp v25, v25, v25 quad_perm:[2,3,0,1] row_mask:0xf bank_mask:0xf
    v_cvt_pk_bf16_f32 v24, v24, v25
    v_and_b32 v25, 0xffff0000, v24
    v_lshlrev_b32 v24, 16, v24
    v_mul_f32 v24, 0x3db504f3, v24
    v_mul_f32 v25, 0x3db504f3, v25
    v_cvt_pk_bf16_f32 v26, v24, v25
    ds_write_b32 v41, v26 offset:5632
    v_and_b32 v25, 0xffff0000, v26
    v_lshlrev_b32 v24, 16, v26
    v_max3_f32 v17, v17, v24, v25
    s_waitcnt vmcnt(22)
    v_dot2_f32_bf16 v18, v160, v8, 0
    v_dot2_f32_bf16 v18, v161, v9, v18
    v_dot2_f32_bf16 v18, v162, v10, v18
    v_dot2_f32_bf16 v18, v163, v11, v18
    s_waitcnt vmcnt(4)
    buffer_load_dwordx4 v[92:95], v0, s[28:31], s41 offen offset:3072 nt
    s_waitcnt vmcnt(22)
    v_dot2_f32_bf16 v19, v164, v8, 0
    v_dot2_f32_bf16 v19, v165, v9, v19
    v_dot2_f32_bf16 v19, v166, v10, v19
    v_dot2_f32_bf16 v19, v167, v11, v19
    s_waitcnt vmcnt(21)
    v_dot2_f32_bf16 v20, v168, v8, 0
    v_dot2_f32_bf16 v20, v169, v9, v20
    v_dot2_f32_bf16 v20, v170, v10, v20
    v_dot2_f32_bf16 v20, v171, v11, v20
    s_waitcnt vmcnt(20)
    v_dot2_f32_bf16 v21, v172, v8, 0
    v_dot2_f32_bf16 v21, v173, v9, v21
    v_dot2_f32_bf16 v21, v174, v10, v21
    v_dot2_f32_bf16 v21, v175, v11, v21
    s_waitcnt vmcnt(4)
    buffer_load_dwordx4 v[96:99], v2, s[28:31], s40 offen offset:0 nt
    v_add_f32_dpp v22, v18, v18 row_ror:8 row_mask:0xf bank_mask:0xf
    v_add_f32_dpp v23, v20, v20 row_ror:8 row_mask:0xf bank_mask:0xf
    v_add_f32_dpp v22, v19, v19 row_ror:8 row_mask:0xf bank_mask:0xc
    v_add_f32_dpp v23, v21, v21 row_ror:8 row_mask:0xf bank_mask:0xc
    s_nop 0
    v_add_f32_dpp v24, v22, v22 row_shl:4 row_mask:0xf bank_mask:0x5
    v_add_f32_dpp v24, v23, v23 row_shr:4 row_mask:0xf bank_mask:0xa
    s_nop 1
    v_add_f32_dpp v24, v24, v24 quad_perm:[1,0,3,2] row_mask:0xf bank_mask:0xf
    s_nop 1
    v_add_f32_dpp v24, v24, v24 quad_perm:[2,3,0,1] row_mask:0xf bank_mask:0xf
    s_waitcnt vmcnt(20)
    v_dot2_f32_bf16 v18, v176, v8, 0
    v_dot2_f32_bf16 v18, v177, v9, v18
    v_dot2_f32_bf16 v18, v178, v10, v18
    v_dot2_f32_bf16 v18, v179, v11, v18
    s_waitcnt vmcnt(19)
    v_dot2_f32_bf16 v19, v180, v8, 0
    v_dot2_f32_bf16 v19, v181, v9, v19
    v_dot2_f32_bf16 v19, v182, v10, v19
    v_dot2_f32_bf16 v19, v183, v11, v19
    s_waitcnt vmcnt(18)
    v_dot2_f32_bf16 v20, v184, v8, 0
    v_dot2_f32_bf16 v20, v185, v9, v20
    v_dot2_f32_bf16 v20, v186, v10, v20
    v_dot2_f32_bf16 v20, v187, v11, v20
    s_waitcnt vmcnt(4)
    buffer_load_dwordx4 v[100:103], v2, s[28:31], s40 offen offset:1024 nt
    s_waitcnt vmcnt(18)
    v_dot2_f32_bf16 v21, v188, v8, 0
    v_dot2_f32_bf16 v21, v189, v9, v21
    v_dot2_f32_bf16 v21, v190, v10, v21
    v_dot2_f32_bf16 v21, v191, v11, v21
    v_add_f32_dpp v22, v18, v18 row_ror:8 row_mask:0xf bank_mask:0xf
    v_add_f32_dpp v23, v20, v20 row_ror:8 row_mask:0xf bank_mask:0xf
    v_add_f32_dpp v22, v19, v19 row_ror:8 row_mask:0xf bank_mask:0xc
    v_add_f32_dpp v23, v21, v21 row_ror:8 row_mask:0xf bank_mask:0xc
    s_nop 0
    v_add_f32_dpp v25, v22, v22 row_shl:4 row_mask:0xf bank_mask:0x5
    v_add_f32_dpp v25, v23, v23 row_shr:4 row_mask:0xf bank_mask:0xa
    s_nop 1
    v_add_f32_dpp v25, v25, v25 quad_perm:[1,0,3,2] row_mask:0xf bank_mask:0xf
    s_nop 1
    v_add_f32_dpp v25, v25, v25 quad_perm:[2,3,0,1] row_mask:0xf bank_mask:0xf
    v_cvt_pk_bf16_f32 v24, v24, v25
    v_and_b32 v25, 0xffff0000, v24
    v_lshlrev_b32 v24, 16, v24
    v_mul_f32 v24, 0x3db504f3, v24
    v_mul_f32 v25, 0x3db504f3, v25
    v_cvt_pk_bf16_f32 v26, v24, v25
    ds_write_b32 v41, v26 offset:5888
    v_and_b32 v25, 0xffff0000, v26
    v_lshlrev_b32 v24, 16, v26
    v_max3_f32 v17, v17, v24, v25
    s_waitcnt vmcnt(17)
    v_dot2_f32_bf16 v18, v192, v8, 0
    v_dot2_f32_bf16 v18, v193, v9, v18
    v_dot2_f32_bf16 v18, v194, v10, v18
    v_dot2_f32_bf16 v18, v195, v11, v18
    s_waitcnt vmcnt(16)
    v_dot2_f32_bf16 v19, v196, v8, 0
    v_dot2_f32_bf16 v19, v197, v9, v19
    v_dot2_f32_bf16 v19, v198, v10, v19
    v_dot2_f32_bf16 v19, v199, v11, v19
    s_waitcnt vmcnt(15)
    v_dot2_f32_bf16 v20, v200, v8, 0
    v_dot2_f32_bf16 v20, v201, v9, v20
    v_dot2_f32_bf16 v20, v202, v10, v20
    v_dot2_f32_bf16 v20, v203, v11, v20
    s_waitcnt vmcnt(4)
    buffer_load_dwordx4 v[104:107], v2, s[28:31], s40 offen offset:2048 nt
    s_waitcnt vmcnt(15)
    v_dot2_f32_bf16 v21, v204, v8, 0
    v_dot2_f32_bf16 v21, v205, v9, v21
    v_dot2_f32_bf16 v21, v206, v10, v21
    v_dot2_f32_bf16 v21, v207, v11, v21
    v_add_f32_dpp v22, v18, v18 row_ror:8 row_mask:0xf bank_mask:0xf
    v_add_f32_dpp v23, v20, v20 row_ror:8 row_mask:0xf bank_mask:0xf
    v_add_f32_dpp v22, v19, v19 row_ror:8 row_mask:0xf bank_mask:0xc
    v_add_f32_dpp v23, v21, v21 row_ror:8 row_mask:0xf bank_mask:0xc
    s_nop 0
    v_add_f32_dpp v24, v22, v22 row_shl:4 row_mask:0xf bank_mask:0x5
    v_add_f32_dpp v24, v23, v23 row_shr:4 row_mask:0xf bank_mask:0xa
    s_nop 1
    v_add_f32_dpp v24, v24, v24 quad_perm:[1,0,3,2] row_mask:0xf bank_mask:0xf
    s_nop 1
    v_add_f32_dpp v24, v24, v24 quad_perm:[2,3,0,1] row_mask:0xf bank_mask:0xf
    s_waitcnt vmcnt(14)
    v_dot2_f32_bf16 v18, v208, v8, 0
    v_dot2_f32_bf16 v18, v209, v9, v18
    v_dot2_f32_bf16 v18, v210, v10, v18
    v_dot2_f32_bf16 v18, v211, v11, v18
    s_waitcnt vmcnt(13)
    v_dot2_f32_bf16 v19, v212, v8, 0
    v_dot2_f32_bf16 v19, v213, v9, v19
    v_dot2_f32_bf16 v19, v214, v10, v19
    v_dot2_f32_bf16 v19, v215, v11, v19
    s_waitcnt vmcnt(4)
    buffer_load_dwordx4 v[108:111], v2, s[28:31], s40 offen offset:3072 nt
    s_waitcnt vmcnt(13)
    v_dot2_f32_bf16 v20, v216, v8, 0
    v_dot2_f32_bf16 v20, v217, v9, v20
    v_dot2_f32_bf16 v20, v218, v10, v20
    v_dot2_f32_bf16 v20, v219, v11, v20
    s_waitcnt vmcnt(12)
    v_dot2_f32_bf16 v21, v220, v8, 0
    v_dot2_f32_bf16 v21, v221, v9, v21
    v_dot2_f32_bf16 v21, v222, v10, v21
    v_dot2_f32_bf16 v21, v223, v11, v21
    v_add_f32_dpp v22, v18, v18 row_ror:8 row_mask:0xf bank_mask:0xf
    v_add_f32_dpp v23, v20, v20 row_ror:8 row_mask:0xf bank_mask:0xf
    v_add_f32_dpp v22, v19, v19 row_ror:8 row_mask:0xf bank_mask:0xc
    v_add_f32_dpp v23, v21, v21 row_ror:8 row_mask:0xf bank_mask:0xc
    s_nop 0
    v_add_f32_dpp v25, v22, v22 row_shl:4 row_mask:0xf bank_mask:0x5
    v_add_f32_dpp v25, v23, v23 row_shr:4 row_mask:0xf bank_mask:0xa
    s_nop 1
    v_add_f32_dpp v25, v25, v25 quad_perm:[1,0,3,2] row_mask:0xf bank_mask:0xf
    s_nop 1
    v_add_f32_dpp v25, v25, v25 quad_perm:[2,3,0,1] row_mask:0xf bank_mask:0xf
    v_cvt_pk_bf16_f32 v24, v24, v25
    v_and_b32 v25, 0xffff0000, v24
    v_lshlrev_b32 v24, 16, v24
    v_mul_f32 v24, 0x3db504f3, v24
    v_mul_f32 v25, 0x3db504f3, v25
    v_cvt_pk_bf16_f32 v26, v24, v25
    ds_write_b32 v41, v26 offset:6144
    v_and_b32 v25, 0xffff0000, v26
    v_lshlrev_b32 v24, 16, v26
    v_max3_f32 v17, v17, v24, v25
    s_waitcnt vmcnt(11)
    v_dot2_f32_bf16 v18, v64, v8, 0
    v_dot2_f32_bf16 v18, v65, v9, v18
    v_dot2_f32_bf16 v18, v66, v10, v18
    v_dot2_f32_bf16 v18, v67, v11, v18
    s_waitcnt vmcnt(4)
    buffer_load_dwordx4 v[112:115], v0, s[28:31], s40 offen offset:0 nt
    s_waitcnt vmcnt(11)
    v_dot2_f32_bf16 v19, v68, v8, 0
    v_dot2_f32_bf16 v19, v69, v9, v19
    v_dot2_f32_bf16 v19, v70, v10, v19
    v_dot2_f32_bf16 v19, v71, v11, v19
    s_waitcnt vmcnt(10)
    v_dot2_f32_bf16 v20, v72, v8, 0
    v_dot2_f32_bf16 v20, v73, v9, v20
    v_dot2_f32_bf16 v20, v74, v10, v20
    v_dot2_f32_bf16 v20, v75, v11, v20
    s_waitcnt vmcnt(9)
    v_dot2_f32_bf16 v21, v76, v8, 0
    v_dot2_f32_bf16 v21, v77, v9, v21
    v_dot2_f32_bf16 v21, v78, v10, v21
    v_dot2_f32_bf16 v21, v79, v11, v21
    v_add_f32_dpp v22, v18, v18 row_ror:8 row_mask:0xf bank_mask:0xf
    v_add_f32_dpp v23, v20, v20 row_ror:8 row_mask:0xf bank_mask:0xf
    v_add_f32_dpp v22, v19, v19 row_ror:8 row_mask:0xf bank_mask:0xc
    v_add_f32_dpp v23, v21, v21 row_ror:8 row_mask:0xf bank_mask:0xc
    s_nop 0
    v_add_f32_dpp v24, v22, v22 row_shl:4 row_mask:0xf bank_mask:0x5
    v_add_f32_dpp v24, v23, v23 row_shr:4 row_mask:0xf bank_mask:0xa
    s_nop 1
    v_add_f32_dpp v24, v24, v24 quad_perm:[1,0,3,2] row_mask:0xf bank_mask:0xf
    s_nop 1
    v_add_f32_dpp v24, v24, v24 quad_perm:[2,3,0,1] row_mask:0xf bank_mask:0xf
    s_waitcnt vmcnt(8)
    v_dot2_f32_bf16 v18, v80, v8, 0
    v_dot2_f32_bf16 v18, v81, v9, v18
    v_dot2_f32_bf16 v18, v82, v10, v18
    v_dot2_f32_bf16 v18, v83, v11, v18
    s_waitcnt vmcnt(4)
    buffer_load_dwordx4 v[116:119], v0, s[28:31], s40 offen offset:1024 nt
    s_waitcnt vmcnt(8)
    v_dot2_f32_bf16 v19, v84, v8, 0
    v_dot2_f32_bf16 v19, v85, v9, v19
    v_dot2_f32_bf16 v19, v86, v10, v19
    v_dot2_f32_bf16 v19, v87, v11, v19
    s_waitcnt vmcnt(7)
    v_dot2_f32_bf16 v20, v88, v8, 0
    v_dot2_f32_bf16 v20, v89, v9, v20
    v_dot2_f32_bf16 v20, v90, v10, v20
    v_dot2_f32_bf16 v20, v91, v11, v20
    s_waitcnt vmcnt(6)
    v_dot2_f32_bf16 v21, v92, v8, 0
    v_dot2_f32_bf16 v21, v93, v9, v21
    v_dot2_f32_bf16 v21, v94, v10, v21
    v_dot2_f32_bf16 v21, v95, v11, v21
    s_waitcnt vmcnt(4)
    buffer_load_dwordx4 v[120:123], v0, s[28:31], s40 offen offset:2048 nt
    v_add_f32_dpp v22, v18, v18 row_ror:8 row_mask:0xf bank_mask:0xf
    v_add_f32_dpp v23, v20, v20 row_ror:8 row_mask:0xf bank_mask:0xf
    v_add_f32_dpp v22, v19, v19 row_ror:8 row_mask:0xf bank_mask:0xc
    v_add_f32_dpp v23, v21, v21 row_ror:8 row_mask:0xf bank_mask:0xc
    s_nop 0
    v_add_f32_dpp v25, v22, v22 row_shl:4 row_mask:0xf bank_mask:0x5
    v_add_f32_dpp v25, v23, v23 row_shr:4 row_mask:0xf bank_mask:0xa
    s_nop 1
    v_add_f32_dpp v25, v25, v25 quad_perm:[1,0,3,2] row_mask:0xf bank_mask:0xf
    s_nop 1
    v_add_f32_dpp v25, v25, v25 quad_perm:[2,3,0,1] row_mask:0xf bank_mask:0xf
    v_cvt_pk_bf16_f32 v24, v24, v25
    v_and_b32 v25, 0xffff0000, v24
    v_lshlrev_b32 v24, 16, v24
    v_mul_f32 v24, 0x3db504f3, v24
    v_mul_f32 v25, 0x3db504f3, v25
    v_cvt_pk_bf16_f32 v26, v24, v25
    ds_write_b32 v41, v26 offset:6400
    v_and_b32 v25, 0xffff0000, v26
    v_lshlrev_b32 v24, 16, v26
    v_max3_f32 v17, v17, v24, v25
    v_add_u32 v41, 1536, v41
    s_mov_b32 s42, 6
    s_memrealtime s[4:5]
    s_cmp_eq_u32 s39, 0
    s_cselect_b32 s46, 49213166, 0
    s_mov_b32 s47, 1
    s_mov_b32 s15, 0
    ds_read_b32 v254, v3 offset:2404
L_kloop:
    s_add_u32 s42, s42, 1
    s_and_b32 s42, s42, 15
    s_cselect_b32 s96, s28, s32
    s_cselect_b32 s97, s29, s33
    s_lshl_b32 s3, s42, 18
    s_xor_b32 s41, s43, s3
    s_waitcnt lgkmcnt(0)
    v_readfirstlane_b32 s3, v254
    s_lshr_b32 s46, s46, 1
    s_bitcmp1_b32 s46, 0
    s_nop 1
    s_cbranch_scc1 L_cpk
L_cbk:
    s_lshl_b32 s14, s4, 4
    s_sub_u32 s14, s14, s15
    s_sub_u32 s14, s14, s3
    s_add_u32 s15, s15, 1728
    s_cmp_eq_u32 s3, 0
    s_cselect_b32 s14, 0, s14
    s_add_u32 s14, s14, 4294967136
    s_cmp_le_i32 s14, 0
    s_cselect_b64 vcc, -1, 0
    s_mov_b32 s3, 800
    s_cselect_b32 s3, -720, s3
    s_cmp_lt_i32 s14, s3
    s_waitcnt vmcnt(6)
    s_cbranch_vccz L_u1
    s_waitcnt vmcnt(4)
    s_cbranch_scc0 L_t1
    s_waitcnt vmcnt(3)
L_u1:
    s_cbranch_scc0 L_t1
    s_waitcnt vmcnt(5)
L_t1:
    buffer_load_dwordx4 v[124:127], v0, s[28:31], s40 offen offset:3072 nt
    v_dot2_f32_bf16 v18, v96, v8, 0
    v_dot2_f32_bf16 v18, v97, v9, v18
    v_dot2_f32_bf16 v18, v98, v10, v18
    v_dot2_f32_bf16 v18, v99, v11, v18
    s_waitcnt vmcnt(6)
    s_cbranch_vccz L_u2
    s_waitcnt vmcnt(4)
    s_cbranch_scc0 L_t2
    s_waitcnt vmcnt(3)
L_u2:
    s_cbranch_scc0 L_t2
    s_waitcnt vmcnt(5)
L_t2:
    buffer_load_dwordx4 v[96:99], v2, s[96:99], s41 offen offset:0 nt
    v_dot2_f32_bf16 v19, v100, v8, 0
    v_dot2_f32_bf16 v19, v101, v9, v19
    v_dot2_f32_bf16 v19, v102, v10, v19
    v_dot2_f32_bf16 v19, v103, v11, v19
    s_waitcnt vmcnt(6)
    s_cbranch_vccz L_u3
    s_waitcnt vmcnt(4)
    s_cbranch_scc0 L_t3
    s_waitcnt vmcnt(3)
L_u3:
    s_cbranch_scc0 L_t3
    s_waitcnt vmcnt(5)
L_t3:
    buffer_load_dwordx4 v[100:103], v2, s[96:99], s41 offen offset:1024 nt
    v_dot2_f32_bf16 v20, v104, v8, 0
    v_dot2_f32_bf16 v20, v105, v9, v20
    v_dot2_f32_bf16 v20, v106, v10, v20
    v_dot2_f32_bf16 v20, v107, v11, v20
    s_waitcnt vmcnt(6)
    s_cbranch_vccz L_u4
    s_waitcnt vmcnt(4)
    s_cbranch_scc0 L_t4
    s_waitcnt vmcnt(3)
L_u4:
    s_cbranch_scc0 L_t4
    s_waitcnt vmcnt(5)
L_t4:
    buffer_load_dwordx4 v[104:107], v2, s[96:99], s41 offen offset:2048 nt
    v_dot2_f32_bf16 v21, v108, v8, 0
    v_dot2_f32_bf16 v21, v109, v9, v21
    v_dot2_f32_bf16 v21, v110, v10, v21
    v_dot2_f32_bf16 v21, v111, v11, v21
    v_add_f32_dpp v22, v18, v18 row_ror:8 row_mask:0xf bank_mask:0xf
    v_add_f32_dpp v23, v20, v20 row_ror:8 row_mask:0xf bank_mask:0xf
    v_add_f32_dpp v22, v19, v19 row_ror:8 row_mask:0xf bank_mask:0xc
    v_add_f32_dpp v23, v21, v21 row_ror:8 row_mask:0xf bank_mask:0xc
    s_nop 0
    v_add_f32_dpp v24, v22, v22 row_shl:4 row_mask:0xf bank_mask:0x5
    v_add_f32_dpp v24, v23, v23 row_shr:4 row_mask:0xf bank_mask:0xa
    s_nop 1
    v_add_f32_dpp v24, v24, v24 quad_perm:[1,0,3,2] row_mask:0xf bank_mask:0xf
    s_nop 1
    v_add_f32_dpp v24, v24, v24 quad_perm:[2,3,0,1] row_mask:0xf bank_mask:0xf
    s_waitcnt vmcnt(6)
    s_cbranch_vccz L_u5
    s_waitcnt vmcnt(4)
    s_cbranch_scc0 L_t5
    s_waitcnt vmcnt(3)
L_u5:
    s_cbranch_scc0 L_t5
    s_waitcnt vmcnt(5)
L_t5:
    buffer_load_dwordx4 v[108:111], v2, s[96:99], s41 offen offset:3072 nt
    v_dot2_f32_bf16 v18, v112, v8, 0
    v_dot2_f32_bf16 v18, v113, v9, v18
    v_dot2_f32_bf16 v18, v114, v10, v18
    v_dot2_f32_bf16 v18, v115, v11, v18
    s_waitcnt vmcnt(6)
    s_cbranch_vccz L_u6
    s_waitcnt vmcnt(4)
    s_cbranch_scc0 L_t6
    s_waitcnt vmcnt(3)
L_u6:
    s_cbranch_scc0 L_t6
    s_waitcnt vmcnt(5)
L_t6:
    buffer_load_dwordx4 v[112:115], v0, s[96:99], s41 offen offset:0 nt
    v_dot2_f32_bf16 v19, v116, v8, 0
    v_dot2_f32_bf16 v19, v117, v9, v19
    v_dot2_f32_bf16 v19, v118, v10, v19
    v_dot2_f32_bf16 v19, v119, v11, v19
    s_waitcnt vmcnt(6)
    s_cbranch_vccz L_u7
    s_waitcnt vmcnt(4)
    s_cbranch_scc0 L_t7
    s_waitcnt vmcnt(3)
L_u7:
    s_cbranch_scc0 L_t7
    s_waitcnt vmcnt(5)
L_t7:
    buffer_load_dwordx4 v[116:119], v0, s[96:99], s41 offen offset:1024 nt
    v_dot2_f32_bf16 v20, v120, v8, 0
    v_dot2_f32_bf16 v20, v121, v9, v20
    v_dot2_f32_bf16 v20, v122, v10, v20
    v_dot2_f32_bf16 v20, v123, v11, v20
    s_waitcnt vmcnt(6)
    s_cbranch_vccz L_u8
    s_waitcnt vmcnt(4)
    s_cbranch_scc0 L_t8
    s_waitcnt vmcnt(3)
L_u8:
    s_cbranch_scc0 L_t8
    s_waitcnt vmcnt(5)
L_t8:
    s_memrealtime s[4:5]
    ds_read_b32 v254, v3 offset:2404
    buffer_load_dwordx4 v[120:123], v0, s[96:99], s41 offen offset:2048 nt
    v_dot2_f32_bf16 v21, v124, v8, 0
    v_dot2_f32_bf16 v21, v125, v9, v21
    v_dot2_f32_bf16 v21, v126, v10, v21
    v_dot2_f32_bf16 v21, v127, v11, v21
    v_add_f32_dpp v22, v18, v18 row_ror:8 row_mask:0xf bank_mask:0xf
    v_add_f32_dpp v23, v20, v20 row_ror:8 row_mask:0xf bank_mask:0xf
    v_add_f32_dpp v22, v19, v19 row_ror:8 row_mask:0xf bank_mask:0xc
    v_add_f32_dpp v23, v21, v21 row_ror:8 row_mask:0xf bank_mask:0xc
    s_nop 0
    v_add_f32_dpp v25, v22, v22 row_shl:4 row_mask:0xf bank_mask:0x5
    v_add_f32_dpp v25, v23, v23 row_shr:4 row_mask:0xf bank_mask:0xa
    s_nop 1
    v_add_f32_dpp v25, v25, v25 quad_perm:[1,0,3,2] row_mask:0xf bank_mask:0xf
    s_nop 1
    v_add_f32_dpp v25, v25, v25 quad_perm:[2,3,0,1] row_mask:0xf bank_mask:0xf
    v_cvt_pk_bf16_f32 v24, v24, v25
    v_and_b32 v25, 0xffff0000, v24
    v_lshlrev_b32 v24, 16, v24
    v_mul_f32 v24, 0x3db504f3, v24
    v_mul_f32 v25, 0x3db504f3, v25
    v_cvt_pk_bf16_f32 v26, v24, v25
    ds_write_b32 v41, v26 offset:5120
    v_and_b32 v25, 0xffff0000, v26
    v_lshlrev_b32 v24, 16, v26
    v_max3_f32 v17, v17, v24, v25
    v_add_u32 v41, 256, v41
    s_mov_b32 s40, s41
    s_cmp_lg_u32 s42, 0
    s_cbranch_scc1 L_kloop
    v_subrev_u32 v41, 4096, v41
    v_max_f32_dpp v17, v17, v17 row_ror:4 row_mask:0xf bank_mask:0xf
    ds_read_b32 v26, v41 offset:5120
    s_nop 0
    v_max_f32_dpp v17, v17, v17 row_ror:8 row_mask:0xf bank_mask:0xf
    s_cmp_lt_u32 s53, 16
    s_cselect_b32 s96, 12, 99
    s_mov_b32 s97, 320
    s_cselect_b32 s97, -320, s97
    v_max_f32_dpp v17, v17, v17 row_bcast:15 row_mask:0xa bank_mask:0xf
    s_nop 1
    v_max_f32_dpp v17, v17, v17 row_bcast:31 row_mask:0xc bank_mask:0xf
    s_nop 0
    v_readlane_b32 s3, v17, 63
    s_nop 1
    v_mov_b32 v17, s3
    v_lshrrev_b32 v28, 1, v37
    ds_write_b32 v28, v17 offset:5056
    s_nop 0
L_vloop:
    s_cmp_eq_u32 s42, 12
    s_cbranch_scc1 L_prep
L_vloop2:
    s_add_u32 s42, s42, 1
    s_lshl_b32 s3, s42, 18
    s_xor_b32 s41, s43, s3
    s_waitcnt lgkmcnt(0)
    v_readfirstlane_b32 s3, v254
    s_lshr_b32 s46, s46, 1
    s_bitcmp1_b32 s46, 0
    s_nop 1
    s_cbranch_scc1 L_cpv
L_cbv:
    s_lshl_b32 s14, s4, 4
    s_sub_u32 s14, s14, s15
    s_sub_u32 s14, s14, s3
    s_add_u32 s15, s15, 1712
    s_add_u32 s14, s14, s97
    s_cmp_eq_u32 s3, 0
    s_cselect_b32 s14, 0, s14
    s_cmp_le_i32 s14, 0
    s_cselect_b64 vcc, -1, 0
    s_mov_b32 s3, 640
    s_cselect_b32 s3, -320, s3
    s_cmp_lt_i32 s14, s3
    v_and_b32 v25, 0xffff0000, v26
    v_lshlrev_b32 v24, 16, v26
    v_add_u32 v41, 256, v41
    ds_read_b32 v26, v41 offset:5120
    v_sub_f32 v24, v24, v17
    v_sub_f32 v25, v25, v17
    v_mul_f32 v24, 0x3fb8aa3b, v24
    v_mul_f32 v25, 0x3fb8aa3b, v25
    v_exp_f32 v24, v24
    v_exp_f32 v25, v25
    v_add_f32 v16, v16, v24
    v_cvt_pk_bf16_f32 v22, v24, v24
    v_cvt_pk_bf16_f32 v23, v25, v25
    v_add_f32 v16, v16, v25
    v_and_b32_dpp v28, v22, v4 row_newbcast:0 row_mask:0xf bank_mask:0xf
    v_and_b32_dpp v29, v22, v5 row_newbcast:0 row_mask:0xf bank_mask:0xf
    v_and_b32_dpp v30, v22, v6 row_newbcast:0 row_mask:0xf bank_mask:0xf
    v_and_b32_dpp v31, v22, v7 row_newbcast:0 row_mask:0xf bank_mask:0xf
    s_waitcnt vmcnt(6)
    s_cbranch_vccz L_u9
    s_waitcnt vmcnt(4)
    s_cbranch_scc0 L_t9
    s_waitcnt vmcnt(3)
L_u9:
    s_cbranch_scc0 L_t9
    s_waitcnt vmcnt(5)
L_t9:
    buffer_load_dwordx4 v[124:127], v0, s[32:35], s40 offen offset:3072 nt
    v_mfma_f32_16x16x32_bf16 v[12:15], v[28:31], v[96:99], v[12:15]
    v_and_b32_dpp v32, v22, v4 row_newbcast:8 row_mask:0xf bank_mask:0xf
    v_and_b32_dpp v33, v22, v5 row_newbcast:8 row_mask:0xf bank_mask:0xf
    v_and_b32_dpp v34, v22, v6 row_newbcast:8 row_mask:0xf bank_mask:0xf
    v_and_b32_dpp v35, v22, v7 row_newbcast:8 row_mask:0xf bank_mask:0xf
    s_waitcnt vmcnt(6)
    s_cbranch_vccz L_u10
    s_waitcnt vmcnt(4)
    s_cbranch_scc0 L_t10
    s_waitcnt vmcnt(3)
L_u10:
    s_cbranch_scc0 L_t10
    s_waitcnt vmcnt(5)
L_t10:
    buffer_load_dwordx4 v[96:99], v2, s[32:35], s41 offen offset:0 nt
    v_mfma_f32_16x16x32_bf16 v[12:15], v[32:35], v[100:103], v[12:15]
    v_and_b32_dpp v28, v22, v4 row_newbcast:4 row_mask:0xf bank_mask:0xf
    v_and_b32_dpp v29, v22, v5 row_newbcast:4 row_mask:0xf bank_mask:0xf
    v_and_b32_dpp v30, v22, v6 row_newbcast:4 row_mask:0xf bank_mask:0xf
    v_and_b32_dpp v31, v22, v7 row_newbcast:4 row_mask:0xf bank_mask:0xf
    s_waitcnt vmcnt(6)
    s_cbranch_vccz L_u11
    s_waitcnt vmcnt(4)
    s_cbranch_scc0 L_t11
    s_waitcnt vmcnt(3)
L_u11:
    s_cbranch_scc0 L_t11
    s_waitcnt vmcnt(5)
L_t11:
    buffer_load_dwordx4 v[100:103], v2, s[32:35], s41 offen offset:1024 nt
    v_mfma_f32_16x16x32_bf16 v[12:15], v[28:31], v[104:107], v[12:15]
    v_and_b32_dpp v32, v22, v4 row_newbcast:12 row_mask:0xf bank_mask:0xf
    v_and_b32_dpp v33, v22, v5 row_newbcast:12 row_mask:0xf bank_mask:0xf
    v_and_b32_dpp v34, v22, v6 row_newbcast:12 row_mask:0xf bank_mask:0xf
    v_and_b32_dpp v35, v22, v7 row_newbcast:12 row_mask:0xf bank_mask:0xf
    s_waitcnt vmcnt(6)
    s_cbranch_vccz L_u12
    s_waitcnt vmcnt(4)
    s_cbranch_scc0 L_t12
    s_waitcnt vmcnt(3)
L_u12:
    s_cbranch_scc0 L_t12
    s_waitcnt vmcnt(5)
L_t12:
    buffer_load_dwordx4 v[104:107], v2, s[32:35], s41 offen offset:2048 nt
    v_mfma_f32_16x16x32_bf16 v[12:15], v[32:35], v[108:111], v[12:15]
    v_and_b32_dpp v28, v23, v4 row_newbcast:0 row_mask:0xf bank_mask:0xf
    v_and_b32_dpp v29, v23, v5 row_newbcast:0 row_mask:0xf bank_mask:0xf
    v_and_b32_dpp v30, v23, v6 row_newbcast:0 row_mask:0xf bank_mask:0xf
    v_and_b32_dpp v31, v23, v7 row_newbcast:0 row_mask:0xf bank_mask:0xf
    s_waitcnt vmcnt(6)
    s_cbranch_vccz L_u13
    s_waitcnt vmcnt(4)
    s_cbranch_scc0 L_t13
    s_waitcnt vmcnt(3)
L_u13:
    s_cbranch_scc0 L_t13
    s_waitcnt vmcnt(5)
L_t13:
    buffer_load_dwordx4 v[108:111], v2, s[32:35], s41 offen offset:3072 nt
    v_mfma_f32_16x16x32_bf16 v[12:15], v[28:31], v[112:115], v[12:15]
    v_and_b32_dpp v32, v23, v4 row_newbcast:8 row_mask:0xf bank_mask:0xf
    v_and_b32_dpp v33, v23, v5 row_newbcast:8 row_mask:0xf bank_mask:0xf
    v_and_b32_dpp v34, v23, v6 row_newbcast:8 row_mask:0xf bank_mask:0xf
    v_and_b32_dpp v35, v23, v7 row_newbcast:8 row_mask:0xf bank_mask:0xf
    s_waitcnt vmcnt(6)
    s_cbranch_vccz L_u14
    s_waitcnt vmcnt(4)
    s_cbranch_scc0 L_t14
    s_waitcnt vmcnt(3)
L_u14:
    s_cbranch_scc0 L_t14
    s_waitcnt vmcnt(5)
L_t14:
    buffer_load_dwordx4 v[112:115], v0, s[32:35], s41 offen offset:0 nt
    v_mfma_f32_16x16x32_bf16 v[12:15], v[32:35], v[116:119], v[12:15]
    v_and_b32_dpp v28, v23, v4 row_newbcast:4 row_mask:0xf bank_mask:0xf
    v_and_b32_dpp v29, v23, v5 row_newbcast:4 row_mask:0xf bank_mask:0xf
    v_and_b32_dpp v30, v23, v6 row_newbcast:4 row_mask:0xf bank_mask:0xf
    v_and_b32_dpp v31, v23, v7 row_newbcast:4 row_mask:0xf bank_mask:0xf
    s_waitcnt vmcnt(6)
    s_cbranch_vccz L_u15
    s_waitcnt vmcnt(4)
    s_cbranch_scc0 L_t15
    s_waitcnt vmcnt(3)
L_u15:
    s_cbranch_scc0 L_t15
    s_waitcnt vmcnt(5)
L_t15:
    buffer_load_dwordx4 v[116:119], v0, s[32:35], s41 offen offset:1024 nt
    v_mfma_f32_16x16x32_bf16 v[12:15], v[28:31], v[120:123], v[12:15]
    v_and_b32_dpp v32, v23, v4 row_newbcast:12 row_mask:0xf bank_mask:0xf
    v_and_b32_dpp v33, v23, v5 row_newbcast:12 row_mask:0xf bank_mask:0xf
    v_and_b32_dpp v34, v23, v6 row_newbcast:12 row_mask:0xf bank_mask:0xf
    v_and_b32_dpp v35, v23, v7 row_newbcast:12 row_mask:0xf bank_mask:0xf
    s_waitcnt vmcnt(6)
    s_cbranch_vccz L_u16
    s_waitcnt vmcnt(4)
    s_cbranch_scc0 L_t16
    s_waitcnt vmcnt(3)
L_u16:
    s_cbranch_scc0 L_t16
    s_waitcnt vmcnt(5)
L_t16:
    s_memrealtime s[4:5]
    ds_read_b32 v254, v3 offset:2404
    buffer_load_dwordx4 v[120:123], v0, s[32:35], s41 offen offset:2048 nt
    v_mfma_f32_16x16x32_bf16 v[12:15], v[32:35], v[124:127], v[12:15]
    s_mov_b32 s40, s41
    s_cmp_lt_u32 s42, 15
    s_cbranch_scc1 L_vloop
    buffer_load_dwordx4 v[124:127], v0, s[32:35], s40 offen offset:3072 nt
    s_waitcnt lgkmcnt(0)
    v_and_b32 v25, 0xffff0000, v26
    v_lshlrev_b32 v24, 16, v26
    v_sub_f32 v24, v24, v17
    v_sub_f32 v25, v25, v17
    v_mul_f32 v24, 0x3fb8aa3b, v24
    v_mul_f32 v25, 0x3fb8aa3b, v25
    v_exp_f32 v24, v24
    v_exp_f32 v25, v25
    v_add_f32 v16, v16, v24
    v_cvt_pk_bf16_f32 v22, v24, v24
    v_cvt_pk_bf16_f32 v23, v25, v25
    v_add_f32 v16, v16, v25
    s_nop 1
    v_add_f32_dpp v16, v16, v16 row_ror:4 row_mask:0xf bank_mask:0xf
    s_nop 1
    v_add_f32_dpp v16, v16, v16 row_ror:8 row_mask:0xf bank_mask:0xf
    s_nop 1
    v_add_f32_dpp v16, v16, v16 row_bcast:15 row_mask:0xa bank_mask:0xf
    s_nop 1
    v_add_f32_dpp v16, v16, v16 row_bcast:31 row_mask:0xc bank_mask:0xf
    s_mov_b32 exec_lo, 0
    s_mov_b32 exec_hi, 0x80000000
    ds_write_b32 v37, v16 offset:2368
    s_mov_b64 exec, -1
    v_and_b32_dpp v28, v22, v4 row_newbcast:0 row_mask:0xf bank_mask:0xf
    v_and_b32_dpp v29, v22, v5 row_newbcast:0 row_mask:0xf bank_mask:0xf
    v_and_b32_dpp v30, v22, v6 row_newbcast:0 row_mask:0xf bank_mask:0xf
    v_and_b32_dpp v31, v22, v7 row_newbcast:0 row_mask:0xf bank_mask:0xf
    s_waitcnt vmcnt(7)
    s_nop 0
    v_mfma_f32_16x16x32_bf16 v[12:15], v[28:31], v[96:99], v[12:15]
    v_and_b32_dpp v32, v22, v4 row_newbcast:8 row_mask:0xf bank_mask:0xf
    v_and_b32_dpp v33, v22, v5 row_newbcast:8 row_mask:0xf bank_mask:0xf
    v_and_b32_dpp v34, v22, v6 row_newbcast:8 row_mask:0xf bank_mask:0xf
    v_and_b32_dpp v35, v22, v7 row_newbcast:8 row_mask:0xf bank_mask:0xf
    s_waitcnt vmcnt(6)
    s_nop 0
    v_mfma_f32_16x16x32_bf16 v[12:15], v[32:35], v[100:103], v[12:15]
    v_and_b32_dpp v28, v22, v4 row_newbcast:4 row_mask:0xf bank_mask:0xf
    v_and_b32_dpp v29, v22, v5 row_newbcast:4 row_mask:0xf bank_mask:0xf
    v_and_b32_dpp v30, v22, v6 row_newbcast:4 row_mask:0xf bank_mask:0xf
    v_and_b32_dpp v31, v22, v7 row_newbcast:4 row_mask:0xf bank_mask:0xf
    s_waitcnt vmcnt(5)
    s_nop 0
    v_mfma_f32_16x16x32_bf16 v[12:15], v[28:31], v[104:107], v[12:15]
    v_and_b32_dpp v32, v22, v4 row_newbcast:12 row_mask:0xf bank_mask:0xf
    v_and_b32_dpp v33, v22, v5 row_newbcast:12 row_mask:0xf bank_mask:0xf
    v_and_b32_dpp v34, v22, v6 row_newbcast:12 row_mask:0xf bank_mask:0xf
    v_and_b32_dpp v35, v22, v7 row_newbcast:12 row_mask:0xf bank_mask:0xf
    s_waitcnt vmcnt(4)
    s_nop 0
    v_mfma_f32_16x16x32_bf16 v[12:15], v[32:35], v[108:111], v[12:15]
    v_and_b32_dpp v28, v23, v4 row_newbcast:0 row_mask:0xf bank_mask:0xf
    v_and_b32_dpp v29, v23, v5 row_newbcast:0 row_mask:0xf bank_mask:0xf
    v_and_b32_dpp v30, v23, v6 row_newbcast:0 row_mask:0xf bank_mask:0xf
    v_and_b32_dpp v31, v23, v7 row_newbcast:0 row_mask:0xf bank_mask:0xf
    s_waitcnt vmcnt(3)
    s_nop 0
    v_mfma_f32_16x16x32_bf16 v[12:15], v[28:31], v[112:115], v[12:15]
    v_and_b32_dpp v32, v23, v4 row_newbcast:8 row_mask:0xf bank_mask:0xf
    v_and_b32_dpp v33, v23, v5 row_newbcast:8 row_mask:0xf bank_mask:0xf
    v_and_b32_dpp v34, v23, v6 row_newbcast:8 row_mask:0xf bank_mask:0xf
    v_and_b32_dpp v35, v23, v7 row_newbcast:8 row_mask:0xf bank_mask:0xf
    s_waitcnt vmcnt(2)
    s_nop 0
    v_mfma_f32_16x16x32_bf16 v[12:15], v[32:35], v[116:119], v[12:15]
    v_and_b32_dpp v28, v23, v4 row_newbcast:4 row_mask:0xf bank_mask:0xf
    v_and_b32_dpp v29, v23, v5 row_newbcast:4 row_mask:0xf bank_mask:0xf
    v_and_b32_dpp v30, v23, v6 row_newbcast:4 row_mask:0xf bank_mask:0xf
    v_and_b32_dpp v31, v23, v7 row_newbcast:4 row_mask:0xf bank_mask:0xf
    s_waitcnt vmcnt(1)
    s_nop 0
    v_mfma_f32_16x16x32_bf16 v[12:15], v[28:31], v[120:123], v[12:15]
    v_and_b32_dpp v32, v23, v4 row_newbcast:12 row_mask:0xf bank_mask:0xf
    v_and_b32_dpp v33, v23, v5 row_newbcast:12 row_mask:0xf bank_mask:0xf
    v_and_b32_dpp v34, v23, v6 row_newbcast:12 row_mask:0xf bank_mask:0xf
    v_and_b32_dpp v35, v23, v7 row_newbcast:12 row_mask:0xf bank_mask:0xf
    s_waitcnt vmcnt(0)
    s_nop 0
    v_mfma_f32_16x16x32_bf16 v[12:15], v[32:35], v[124:127], v[12:15]
    s_nop 7
    ds_write_b128 v36, v[12:15] offset:256
    s_cmp_eq_u32 s52, 1
    s_waitcnt lgkmcnt(0)
    s_barrier
    ds_read_b64 v[52:53], v38 offset:256
    ds_read_b32 v54, v39 offset:2368
    s_waitcnt lgkmcnt(0)
    v_add_f32_dpp v52, v52, v52 quad_perm:[1,0,3,2] row_mask:0xf bank_mask:0xf
    v_add_f32_dpp v53, v53, v53 quad_perm:[1,0,3,2] row_mask:0xf bank_mask:0xf
    v_add_f32_dpp v54, v54, v54 quad_perm:[1,0,3,2] row_mask:0xf bank_mask:0xf
    v_add_f32_dpp v52, v52, v52 quad_perm:[2,3,0,1] row_mask:0xf bank_mask:0xf
    v_add_f32_dpp v53, v53, v53 quad_perm:[2,3,0,1] row_mask:0xf bank_mask:0xf
    v_add_f32_dpp v54, v54, v54 quad_perm:[2,3,0,1] row_mask:0xf bank_mask:0xf
    v_cvt_pk_bf16_f32 v50, v52, v53
    v_cndmask_b32 v50, v50, v17, s[56:57]
    v_cndmask_b32 v50, v50, v54, s[58:59]
    s_mov_b64 exec, s[50:51]
    s_cbranch_scc0 L_oslow
    global_store_dwordx2 v40, v[50:51], s[26:27]
L_osback:
    s_mov_b64 exec, -1
    s_cmp_ge_u32 s53, 16
    s_cbranch_scc1 L_B
    global_load_dwordx4 v[80:83], v43, s[6:7] sc1
    global_load_dwordx4 v[64:67], v2, s[6:7] offset:0 sc1
    global_load_dwordx4 v[68:71], v2, s[6:7] offset:1024 sc1
    global_load_dwordx4 v[72:75], v2, s[6:7] offset:2048 sc1
    global_load_dwordx4 v[76:79], v2, s[6:7] offset:3072 sc1
L_o_chk:
    s_waitcnt vmcnt(4)
    v_xor_b32 v52, s36, v81
    v_bitop3_b32 v52, v52, s36, v83 bitop3:0xf6
    s_waitcnt vmcnt(3)
    v_bitop3_b32 v52, v52, s36, v65 bitop3:0xf6
    v_bitop3_b32 v52, v52, s36, v67 bitop3:0xf6
    s_waitcnt vmcnt(2)
    v_bitop3_b32 v52, v52, s36, v69 bitop3:0xf6
    v_bitop3_b32 v52, v52, s36, v71 bitop3:0xf6
    s_waitcnt vmcnt(1)
    v_bitop3_b32 v52, v52, s36, v73 bitop3:0xf6
    v_bitop3_b32 v52, v52, s36, v75 bitop3:0xf6
    s_waitcnt vmcnt(0)
    v_bitop3_b32 v52, v52, s36, v77 bitop3:0xf6
    v_bitop3_b32 v52, v52, s36, v79 bitop3:0xf6
    v_cmp_ne_u32 vcc, 0, v52
    s_cbranch_vccz L_o_got
    s_mov_b64 exec, vcc
    global_load_dwordx4 v[80:83], v43, s[6:7] sc1
    global_load_dwordx4 v[64:67], v2, s[6:7] offset:0 sc1
    global_load_dwordx4 v[68:71], v2, s[6:7] offset:1024 sc1
    global_load_dwordx4 v[72:75], v2, s[6:7] offset:2048 sc1
    global_load_dwordx4 v[76:79], v2, s[6:7] offset:3072 sc1
    s_mov_b64 exec, -1
    s_sub_u32 s48, s48, 1
    s_cbranch_scc0 L_o_chk
    s_mov_b32 s48, 0
    s_waitcnt vmcnt(0)
L_o_got:
    v_max_f32_dpp v54, v80, v80 quad_perm:[1,0,3,2] row_mask:0xf bank_mask:0xf
    v_mov_b32 v65, v68
    v_mov_b32 v67, v70
    v_max_f32_dpp v54, v54, v54 quad_perm:[2,3,0,1] row_mask:0xf bank_mask:0xf
    v_mov_b32 v73, v76
    v_mov_b32 v75, v78
    v_max_f32_dpp v54, v54, v54 row_half_mirror row_mask:0xf bank_mask:0xf
    v_mfma_f32_16x16x32_bf16 v[96:99], v[64:67], v[128:131], 0
    v_sub_f32 v80, v80, v54
    v_mul_f32 v80, 0x3fb8aa3b, v80
    v_mfma_f32_16x16x32_bf16 v[100:103], v[64:67], v[132:135], 0
    v_exp_f32 v80, v80
    v_mfma_f32_16x16x32_bf16 v[96:99], v[72:75], v[136:139], v[96:99]
    v_mul_f32 v82, v82, v80
    v_mfma_f32_16x16x32_bf16 v[100:103], v[72:75], v[140:143], v[100:103]
    v_mfma_f32_16x16x32_bf16 v[104:107], v[64:67], v[144:147], 0
    v_add_f32_dpp v82, v82, v82 quad_perm:[1,0,3,2] row_mask:0xf bank_mask:0xf
    v_mfma_f32_16x16x32_bf16 v[108:111], v[64:67], v[148:151], 0
    v_mfma_f32_16x16x32_bf16 v[104:107], v[72:75], v[152:155], v[104:107]
    v_add_f32_dpp v82, v82, v82 quad_perm:[2,3,0,1] row_mask:0xf bank_mask:0xf
    v_mfma_f32_16x16x32_bf16 v[108:111], v[72:75], v[156:159], v[108:111]
    s_nop 0
    v_add_f32_dpp v82, v82, v82 row_half_mirror row_mask:0xf bank_mask:0xf
    v_rcp_f32 v82, v82
    v_mov_b32_dpp v96, v100 quad_perm:[0,1,2,3] row_mask:0xc bank_mask:0xf
    v_mul_f32 v80, v80, v82
    v_mov_b32_dpp v97, v101 quad_perm:[0,1,2,3] row_mask:0xc bank_mask:0xf
    v_mov_b32_dpp v98, v102 quad_perm:[0,1,2,3] row_mask:0xc bank_mask:0xf
    v_mov_b32_dpp v99, v103 quad_perm:[0,1,2,3] row_mask:0xc bank_mask:0xf
    v_mul_f32_dpp v52, v80, v96 row_newbcast:0 row_mask:0xf bank_mask:0xf
    v_fmac_f32_dpp v52, v80, v97 row_newbcast:1 row_mask:0xf bank_mask:0xf
    v_fmac_f32_dpp v52, v80, v98 row_newbcast:2 row_mask:0xf bank_mask:0xf
    v_fmac_f32_dpp v52, v80, v99 row_newbcast:3 row_mask:0xf bank_mask:0xf
    ds_write_b32 v44, v52 offset:2416
    v_mov_b32_dpp v104, v108 quad_perm:[0,1,2,3] row_mask:0xc bank_mask:0xf
    v_mov_b32_dpp v105, v109 quad_perm:[0,1,2,3] row_mask:0xc bank_mask:0xf
    v_mov_b32_dpp v106, v110 quad_perm:[0,1,2,3] row_mask:0xc bank_mask:0xf
    v_mov_b32_dpp v107, v111 quad_perm:[0,1,2,3] row_mask:0xc bank_mask:0xf
    v_mul_f32_dpp v53, v80, v104 row_newbcast:0 row_mask:0xf bank_mask:0xf
    v_fmac_f32_dpp v53, v80, v105 row_newbcast:1 row_mask:0xf bank_mask:0xf
    v_fmac_f32_dpp v53, v80, v106 row_newbcast:2 row_mask:0xf bank_mask:0xf
    v_fmac_f32_dpp v53, v80, v107 row_newbcast:3 row_mask:0xf bank_mask:0xf
    ds_write_b32 v44, v53 offset:3696
    s_cmp_ge_u32 s39, 2
    s_waitcnt lgkmcnt(0)
    s_barrier
    s_cbranch_scc1 L_down
    ds_read_b128 v[52:55], v45 offset:2416
    s_mov_b32 s50, s51
    s_waitcnt lgkmcnt(0)
    v_add_f32 v52, v52, v53
    v_add_f32 v54, v54, v55
    v_add_f32 v52, v52, v54
    s_nop 1
    v_add_f32_dpp v52, v52, v52 quad_perm:[1,0,3,2] row_mask:0xf bank_mask:0xf
    s_nop 1
    v_add_f32_dpp v50, v52, v52 quad_perm:[2,3,0,1] row_mask:0xf bank_mask:0xf
    s_mov_b64 exec, s[50:51]
    global_store_dwordx2 v46, v[50:51], s[26:27] sc1
    s_waitcnt vmcnt(0)
    s_barrier
    s_branch L_fin
L_down:
    s_and_b32 s3, s39, 1
    s_mul_i32 s3, s3, 7168
    s_add_u32 m0, s3, 59392
    s_barrier
    global_load_lds_dwordx4 v58, s[20:21] offset:-3072
    v_add_u32 v58, 31744, v58
    global_load_lds_dwordx4 v58, s[20:21] offset:-2048
    v_add_u32 v58, 31744, v58
    global_load_lds_dwordx4 v58, s[20:21] offset:-1024
    v_add_u32 v58, 31744, v58
    global_load_lds_dwordx4 v58, s[20:21] offset:0
    v_add_u32 v58, 31744, v58
    global_load_lds_dwordx4 v58, s[20:21] offset:1024
    v_add_u32 v58, 31744, v58
    global_load_lds_dwordx4 v58, s[20:21] offset:2048
    v_add_u32 v58, 31744, v58
    global_load_lds_dwordx4 v58, s[20:21] offset:3072
    global_load_dwordx4 v[64:67], v56, s[60:61] offset:1024 sc1
    s_waitcnt vmcnt(1)
    ds_read_b64_tr_b16 v[192:193], v57 offset:0
    ds_read_b64_tr_b16 v[194:195], v57 offset:128
    ds_read_b64_tr_b16 v[196:197], v57 offset:256
    ds_read_b64_tr_b16 v[198:199], v57 offset:384
    ds_read_b64_tr_b16 v[200:201], v57 offset:512
    ds_read_b64_tr_b16 v[202:203], v57 offset:640
    ds_read_b64_tr_b16 v[204:205], v57 offset:768
    ds_read_b64_tr_b16 v[206:207], v57 offset:896
    ds_read_b64_tr_b16 v[208:209], v57 offset:1024
    ds_read_b64_tr_b16 v[210:211], v57 offset:1152
    ds_read_b64_tr_b16 v[212:213], v57 offset:1280
    ds_read_b64_tr_b16 v[214:215], v57 offset:1408
    ds_read_b64_tr_b16 v[216:217], v57 offset:1536
    ds_read_b64_tr_b16 v[218:219], v57 offset:1664
    s_waitcnt lgkmcnt(0)
L_a_chk:
    s_waitcnt vmcnt(0)
    v_xor_b32 v52, s36, v65
    v_bitop3_b32 v52, v52, s36, v67 bitop3:0xf6
    v_cmp_ne_u32 vcc, 0, v52
    s_cbranch_vccz L_a_got
    s_mov_b64 exec, vcc
    global_load_dwordx4 v[64:67], v56, s[60:61] offset:1024 sc1
    s_mov_b64 exec, -1
    s_sub_u32 s48, s48, 1
    s_cbranch_scc0 L_a_chk
    s_mov_b32 s48, 0
    s_waitcnt vmcnt(0)
L_a_got:
    v_mov_b32_dpp v96, v64 row_newbcast:0 row_mask:0xf bank_mask:0xf
    v_mov_b32_dpp v97, v66 row_newbcast:0 row_mask:0xf bank_mask:0xf
    v_mov_b32_dpp v98, v64 row_newbcast:1 row_mask:0xf bank_mask:0xf
    v_mov_b32_dpp v99, v66 row_newbcast:1 row_mask:0xf bank_mask:0xf
    v_mov_b32_dpp v100, v64 row_newbcast:2 row_mask:0xf bank_mask:0xf
    v_mov_b32_dpp v101, v66 row_newbcast:2 row_mask:0xf bank_mask:0xf
    v_mov_b32_dpp v102, v64 row_newbcast:3 row_mask:0xf bank_mask:0xf
    v_mov_b32_dpp v103, v66 row_newbcast:3 row_mask:0xf bank_mask:0xf
    v_mfma_f32_16x16x32_bf16 v[28:31], v[96:99], v[192:195], 0
    v_mov_b32_dpp v104, v64 row_newbcast:4 row_mask:0xf bank_mask:0xf
    v_mov_b32_dpp v105, v66 row_newbcast:4 row_mask:0xf bank_mask:0xf
    v_mov_b32_dpp v106, v64 row_newbcast:5 row_mask:0xf bank_mask:0xf
    v_mov_b32_dpp v107, v66 row_newbcast:5 row_mask:0xf bank_mask:0xf
    v_mfma_f32_16x16x32_bf16 v[32:35], v[100:103], v[196:199], 0
    v_mov_b32_dpp v108, v64 row_newbcast:6 row_mask:0xf bank_mask:0xf
    v_mov_b32_dpp v109, v66 row_newbcast:6 row_mask:0xf bank_mask:0xf
    v_mov_b32_dpp v110, v64 row_newbcast:7 row_mask:0xf bank_mask:0xf
    v_mov_b32_dpp v111, v66 row_newbcast:7 row_mask:0xf bank_mask:0xf
    v_mfma_f32_16x16x32_bf16 v[28:31], v[104:107], v[200:203], v[28:31]
    v_mov_b32_dpp v112, v64 row_newbcast:8 row_mask:0xf bank_mask:0xf
    v_mov_b32_dpp v113, v66 row_newbcast:8 row_mask:0xf bank_mask:0xf
    v_mov_b32_dpp v114, v64 row_newbcast:9 row_mask:0xf bank_mask:0xf
    v_mov_b32_dpp v115, v66 row_newbcast:9 row_mask:0xf bank_mask:0xf
    v_mfma_f32_16x16x32_bf16 v[32:35], v[108:111], v[204:207], v[32:35]
    v_mov_b32_dpp v116, v64 row_newbcast:10 row_mask:0xf bank_mask:0xf
    v_mov_b32_dpp v117, v66 row_newbcast:10 row_mask:0xf bank_mask:0xf
    v_mov_b32_dpp v118, v64 row_newbcast:11 row_mask:0xf bank_mask:0xf
    v_mov_b32_dpp v119, v66 row_newbcast:11 row_mask:0xf bank_mask:0xf
    v_mfma_f32_16x16x32_bf16 v[28:31], v[112:115], v[208:211], v[28:31]
    v_mov_b32_dpp v120, v64 row_newbcast:12 row_mask:0xf bank_mask:0xf
    v_mov_b32_dpp v121, v66 row_newbcast:12 row_mask:0xf bank_mask:0xf
    v_mov_b32_dpp v122, v64 row_newbcast:13 row_mask:0xf bank_mask:0xf
    v_mov_b32_dpp v123, v66 row_newbcast:13 row_mask:0xf bank_mask:0xf
    v_mfma_f32_16x16x32_bf16 v[32:35], v[116:119], v[212:215], v[32:35]
    s_nop 0
    v_mfma_f32_16x16x32_bf16 v[28:31], v[120:123], v[216:219], v[28:31]
    s_mov_b64 exec, 0xffff
    s_nop 6
    v_add_f32 v50, v28, v32
    global_store_dwordx2 v59, v[50:51], s[10:11] sc1
    s_branch L_fin
L_B:
    s_mul_i32 s3, s39, 8448
    s_add_u32 m0, s3, 21504
    s_mov_b32 exec_lo, 0x0fffffff
    s_mov_b32 exec_hi, 0x0fffffff
    global_load_lds_dwordx4 v[56:57], off nt
    v_add_co_u32 v56, vcc, 3584, v56
    s_add_u32 m0, m0, 1056
    s_nop 0
    v_addc_co_u32 v57, vcc, 0, v57, vcc
    global_load_lds_dwordx4 v[56:57], off nt
    v_add_co_u32 v56, vcc, 3584, v56
    s_add_u32 m0, m0, 1056
    s_nop 0
    v_addc_co_u32 v57, vcc, 0, v57, vcc
    global_load_lds_dwordx4 v[56:57], off nt
    v_add_co_u32 v56, vcc, 3584, v56
    s_add_u32 m0, m0, 1056
    s_nop 0
    v_addc_co_u32 v57, vcc, 0, v57, vcc
    global_load_lds_dwordx4 v[56:57], off nt
    v_add_co_u32 v56, vcc, 17920, v56
    s_add_u32 m0, m0, 1056
    s_nop 0
    v_addc_co_u32 v57, vcc, 0, v57, vcc
    global_load_lds_dwordx4 v[56:57], off nt
    v_add_co_u32 v56, vcc, 3584, v56
    s_add_u32 m0, m0, 1056
    s_nop 0
    v_addc_co_u32 v57, vcc, 0, v57, vcc
    global_load_lds_dwordx4 v[56:57], off nt
    v_add_co_u32 v56, vcc, 3584, v56
    s_add_u32 m0, m0, 1056
    s_nop 0
    v_addc_co_u32 v57, vcc, 0, v57, vcc
    global_load_lds_dwordx4 v[56:57], off nt
    v_add_co_u32 v56, vcc, 3584, v56
    s_add_u32 m0, m0, 1056
    s_nop 0
    v_addc_co_u32 v57, vcc, 0, v57, vcc
    global_load_lds_dwordx4 v[56:57], off nt
    s_mov_b64 exec, s[62:63]
    s_cbranch_execz L_nozt
    global_atomic_add_x2 v[84:85], v58, v[250:251], s[10:11] offset:0 sc0 sc1
    global_atomic_add_x2 v[86:87], v58, v[250:251], s[10:11] offset:512 sc0 sc1
L_nozt:
    s_mov_b64 exec, -1
    v_lshlrev_b32 v60, 16, v60
    global_atomic_add_x2 v[64:65], v43, v[250:251], s[26:27] sc0 sc1
    s_waitcnt vmcnt(0)
    global_atomic_add_x2 v[64:65], v43, v[250:251], s[26:27] sc0 sc1
    s_barrier
    ds_read_b64_tr_b16 v[128:129], v45 offset:0
    ds_read_b64_tr_b16 v[130:131], v45 offset:8448
    ds_read_b64_tr_b16 v[132:133], v45 offset:512
    ds_read_b64_tr_b16 v[134:135], v45 offset:8960
    ds_read_b64_tr_b16 v[136:137], v45 offset:32
    ds_read_b64_tr_b16 v[138:139], v45 offset:8480
    ds_read_b64_tr_b16 v[140:141], v45 offset:544
    ds_read_b64_tr_b16 v[142:143], v45 offset:8992
    ds_read_b64_tr_b16 v[144:145], v45 offset:64
    ds_read_b64_tr_b16 v[146:147], v45 offset:8512
    ds_read_b64_tr_b16 v[148:149], v45 offset:576
    ds_read_b64_tr_b16 v[150:151], v45 offset:9024
    ds_read_b64_tr_b16 v[152:153], v45 offset:96
    ds_read_b64_tr_b16 v[154:155], v45 offset:8544
    ds_read_b64_tr_b16 v[156:157], v45 offset:608
    ds_read_b64_tr_b16 v[158:159], v45 offset:9056
L_y_chk:
    s_waitcnt vmcnt(0)
    v_cmp_ne_u32 vcc, s36, v65
    s_cbranch_vccz L_y_got
    s_mov_b64 exec, vcc
    global_atomic_add_x2 v[64:65], v43, v[250:251], s[26:27] sc0 sc1
    s_mov_b64 exec, -1
    s_sub_u32 s48, s48, 1
    s_cbranch_scc0 L_y_chk
    s_mov_b32 s48, 0
    s_waitcnt vmcnt(0)
L_y_got:
    v_add_f32_dpp v66, v64, v64 row_ror:8 row_mask:0xf bank_mask:0xf
    v_add_f32_dpp v67, v64, v64 row_ror:8 row_mask:0xf bank_mask:0xf
    s_cmp_eq_u32 s52, 1
    s_nop 0
    v_permlane16_swap_b32 v66, v67
    v_add_f32 v64, v66, v67
    v_add_f32 v65, v66, v67
    s_nop 1
    v_permlane32_swap_b32 v64, v65
    v_add_f32 v64, v64, v65
    v_cvt_pk_bf16_f32 v52, v64, v64
    v_and_b32 v52, 0xffff0000, v52
    v_add_f32 v52, v52, v60
    v_cvt_pk_bf16_f32 v52, v52, v52
    ds_write_b16 v44, v52 offset:4976
    s_waitcnt lgkmcnt(0)
    s_barrier
    ds_read_b128 v[28:31], v248 offset:4976
    s_mov_b64 exec, s[24:25]
    ds_read_b128 v[144:147], v61 offset:4976
    s_mov_b64 exec, -1
    s_waitcnt lgkmcnt(0)
    v_mfma_f32_16x16x32_bf16 v[160:163], v[28:31], v[128:131], 0
    v_mfma_f32_16x16x32_bf16 v[164:167], v[28:31], v[132:135], 0
    v_mfma_f32_16x16x32_bf16 v[168:171], v[28:31], v[136:139], 0
    v_mfma_f32_16x16x32_bf16 v[172:175], v[28:31], v[140:143], 0
    v_mfma_f32_16x16x32_bf16 v[176:179], v[28:31], v[144:147], 0
    v_mfma_f32_16x16x32_bf16 v[180:183], v[28:31], v[148:151], 0
    v_mfma_f32_16x16x32_bf16 v[184:187], v[28:31], v[152:155], 0
    v_mfma_f32_16x16x32_bf16 v[188:191], v[28:31], v[156:159], 0
    s_mov_b64 exec, 0xffff
    v_cvt_pk_bf16_f32 v48, v160, v161
    v_cvt_pk_bf16_f32 v50, v164, v165
    s_mov_b32 exec_lo, 0xffff0000
    v_cvt_pk_bf16_f32 v48, v168, v169
    v_cvt_pk_bf16_f32 v50, v172, v173
    s_mov_b32 exec_lo, 0
    s_mov_b32 exec_hi, 0xffff
    v_cvt_pk_bf16_f32 v48, v176, v177
    v_cvt_pk_bf16_f32 v50, v180, v181
    v_cndmask_b32 v48, v48, v176, s[12:13]
    v_cndmask_b32 v50, v50, v177, s[12:13]
    s_mov_b32 exec_hi, 0xffff0000
    v_cvt_pk_bf16_f32 v48, v184, v185
    v_cvt_pk_bf16_f32 v50, v188, v189
    s_mov_b64 exec, -1
    s_cbranch_scc0 L_pslow
    global_store_dwordx4 v46, v[48:51], s[26:27]
    s_nop 1
L_psback:
    s_cmp_lg_u64 s[62:63], 0
    s_cbranch_scc1 L_final
    s_cmp_lg_u32 s39, 1
    s_cbranch_scc1 L_gen
    s_cmp_ge_u32 s49, 14
    s_cbranch_scc1 L_fin
    global_load_dwordx4 v[80:83], v42, s[60:61] sc1
    global_load_dwordx4 v[64:67], v2, s[8:9] offset:0 sc1
    global_load_dwordx4 v[68:71], v2, s[8:9] offset:1024 sc1
    global_load_dwordx4 v[72:75], v2, s[8:9] offset:2048 sc1
    global_load_dwordx4 v[76:79], v2, s[8:9] offset:3072 sc1
L_p_chk:
    s_waitcnt vmcnt(4)
    v_xor_b32 v52, s36, v81
    v_bitop3_b32 v52, v52, s36, v83 bitop3:0xf6
    s_waitcnt vmcnt(3)
    v_bitop3_b32 v52, v52, s36, v65 bitop3:0xf6
    v_bitop3_b32 v52, v52, s36, v67 bitop3:0xf6
    s_waitcnt vmcnt(2)
    v_bitop3_b32 v52, v52, s36, v69 bitop3:0xf6
    v_bitop3_b32 v52, v52, s36, v71 bitop3:0xf6
    s_waitcnt vmcnt(1)
    v_bitop3_b32 v52, v52, s36, v73 bitop3:0xf6
    v_bitop3_b32 v52, v52, s36, v75 bitop3:0xf6
    s_waitcnt vmcnt(0)
    v_bitop3_b32 v52, v52, s36, v77 bitop3:0xf6
    v_bitop3_b32 v52, v52, s36, v79 bitop3:0xf6
    v_cmp_ne_u32 vcc, 0, v52
    s_cbranch_vccz L_p_got
    s_mov_b64 exec, vcc
    global_load_dwordx4 v[80:83], v42, s[60:61] sc1
    global_load_dwordx4 v[64:67], v2, s[8:9] offset:0 sc1
    global_load_dwordx4 v[68:71], v2, s[8:9] offset:1024 sc1
    global_load_dwordx4 v[72:75], v2, s[8:9] offset:2048 sc1
    global_load_dwordx4 v[76:79], v2, s[8:9] offset:3072 sc1
    s_mov_b64 exec, -1
    s_sub_u32 s48, s48, 1
    s_cbranch_scc0 L_p_chk
    s_mov_b32 s48, 0
    s_waitcnt vmcnt(0)
L_p_got:
    v_add_f32_dpp v82, v82, v82 quad_perm:[1,0,3,2] row_mask:0xf bank_mask:0xf
    v_add_f32_dpp v80, v80, v80 quad_perm:[1,0,3,2] row_mask:0xf bank_mask:0xf
    s_nop 0
    v_add_f32_dpp v82, v82, v82 quad_perm:[2,3,0,1] row_mask:0xf bank_mask:0xf
    v_add_f32_dpp v80, v80, v80 quad_perm:[2,3,0,1] row_mask:0xf bank_mask:0xf
    s_nop 0
    v_add_f32_dpp v82, v82, v82 row_half_mirror row_mask:0xf bank_mask:0xf
    v_add_f32_dpp v80, v80, v80 row_half_mirror row_mask:0xf bank_mask:0xf
    s_nop 0
    v_add_f32_dpp v82, v82, v82 row_mirror row_mask:0xf bank_mask:0xf
    v_add_f32_dpp v80, v80, v80 row_mirror row_mask:0xf bank_mask:0xf
    v_mul_f32 v82, 0x3b000000, v82
    v_mul_f32 v80, 0x3b000000, v80
    v_cvt_pk_bf16_f32 v54, 1.0, -v82
    v_fma_f32 v80, -v82, v82, v80
    v_dot2_f32_bf16 v52, v64, v54, 0
    v_dot2_f32_bf16 v53, v66, v54, 0
    v_dot2_f32_bf16 v52, v68, v54, v52
    v_dot2_f32_bf16 v53, v70, v54, v53
    v_dot2_f32_bf16 v52, v72, v54, v52
    v_dot2_f32_bf16 v53, v74, v54, v53
    v_dot2_f32_bf16 v52, v76, v54, v52
    v_dot2_f32_bf16 v53, v78, v54, v53
    v_max_f32 v80, 0, v80
    v_add_f32 v80, 0x3727c5ac, v80
    v_rsq_f32 v80, v80
    v_permlane16_swap_b32 v52, v53
    v_add_f32 v52, v52, v53
    v_mov_b32 v53, v52
    s_cmp_eq_u32 s52, 1
    s_nop 0
    v_permlane32_swap_b32 v52, v53
    v_add_f32 v52, v52, v53
    v_mul_f32 v52, v52, v80
    v_cvt_pk_bf16_f32 v52, v52, v52
    v_and_b32 v52, 0xffff0000, v52
    v_mul_f32 v54, 0xbfb8aa3b, v52
    v_mov_b32 v53, v52
    v_exp_f32 v54, v54
    s_nop 0
    v_permlane16_swap_b32 v52, v53
    v_add_f32 v54, 1.0, v54
    v_rcp_f32 v54, v54
    s_nop 0
    v_mul_f32 v52, v52, v54
    v_cvt_pk_bf16_f32 v52, v52, v52
    v_and_b32 v52, 0xffff0000, v52
    v_mul_f32 v52, v52, v53
    s_nop 1
    v_mov_b32_dpp v53, v52 quad_perm:[1,1,3,3] row_mask:0xf bank_mask:0xf
    v_cvt_pk_bf16_f32 v50, v52, v53
    s_mov_b64 exec, 0x5555
    s_cbranch_scc0 L_aslow
    global_store_dwordx2 v47, v[50:51], s[60:61] offset:1024
    s_branch L_fin
L_aslow:
    global_store_dwordx2 v47, v[50:51], s[60:61] offset:1024 sc1
    s_branch L_fin
L_final:
    v_min_u32 v20, 880, v2
    global_load_dwordx4 v[64:67], v20, s[60:61] offset:1024 sc1
    s_and_b32 s3, s39, 1
    s_lshl_b32 s3, s3, 5
    v_add_u32 v19, s3, v59
    s_waitcnt lgkmcnt(0)
    ds_read_u16 v18, v19 offset:4976
    s_waitcnt lgkmcnt(0)
    v_lshlrev_b32 v18, 16, v18
    s_nop 1
L_f_chk:
    s_waitcnt vmcnt(0)
    v_xor_b32 v52, s36, v65
    v_bitop3_b32 v52, v52, s36, v67 bitop3:0xf6
    v_cmp_ne_u32 vcc, 0, v52
    s_cbranch_vccz L_f_got
    s_mov_b64 exec, vcc
    global_load_dwordx4 v[64:67], v20, s[60:61] offset:1024 sc1
    s_mov_b64 exec, -1
    s_sub_u32 s48, s48, 1
    s_cbranch_scc0 L_f_chk
    s_mov_b32 s48, 0
    s_waitcnt vmcnt(0)
L_f_got:
    s_sleep 4
    global_atomic_add_x2 v[96:97], v58, v[250:251], s[10:11] offset:0 sc0 sc1
    global_atomic_add_x2 v[98:99], v58, v[250:251], s[10:11] offset:512 sc0 sc1
    s_sleep 3
    global_atomic_add_x2 v[100:101], v58, v[250:251], s[10:11] offset:0 sc0 sc1
    global_atomic_add_x2 v[102:103], v58, v[250:251], s[10:11] offset:512 sc0 sc1
    s_sleep 3
    global_atomic_add_x2 v[104:105], v58, v[250:251], s[10:11] offset:0 sc0 sc1
    global_atomic_add_x2 v[106:107], v58, v[250:251], s[10:11] offset:512 sc0 sc1
L_z_loop:
    s_waitcnt vmcnt(4)
    v_xor_b32 v52, s36, v97
    v_bitop3_b32 v52, v52, s36, v99 bitop3:0xf6
    v_cmp_ne_u32 vcc, 0, v52
    s_cbranch_vccz L_z_g0
    global_atomic_add_x2 v[96:97], v58, v[250:251], s[10:11] offset:0 sc0 sc1
    global_atomic_add_x2 v[98:99], v58, v[250:251], s[10:11] offset:512 sc0 sc1
    s_waitcnt vmcnt(4)
    v_xor_b32 v52, s36, v101
    v_bitop3_b32 v52, v52, s36, v103 bitop3:0xf6
    v_cmp_ne_u32 vcc, 0, v52
    s_cbranch_vccz L_z_g1
    global_atomic_add_x2 v[100:101], v58, v[250:251], s[10:11] offset:0 sc0 sc1
    global_atomic_add_x2 v[102:103], v58, v[250:251], s[10:11] offset:512 sc0 sc1
    s_waitcnt vmcnt(4)
    v_xor_b32 v52, s36, v105
    v_bitop3_b32 v52, v52, s36, v107 bitop3:0xf6
    v_cmp_ne_u32 vcc, 0, v52
    s_cbranch_vccz L_z_g2
    global_atomic_add_x2 v[104:105], v58, v[250:251], s[10:11] offset:0 sc0 sc1
    global_atomic_add_x2 v[106:107], v58, v[250:251], s[10:11] offset:512 sc0 sc1
    s_sub_u32 s48, s48, 1
    s_cbranch_scc0 L_z_loop
    s_mov_b32 s48, 0
    s_waitcnt vmcnt(0)
    s_branch L_z_g0
L_z_g2:
    v_add_f32 v52, v104, v106
    s_nop 0
    s_branch L_z_got
L_z_g1:
    v_add_f32 v52, v100, v102
    s_nop 0
    s_branch L_z_got
L_z_g0:
    v_add_f32 v52, v96, v98
    s_nop 1
L_z_got:
    v_mov_b32 v53, v52
    s_nop 1
    v_permlane16_swap_b32 v52, v53
    v_add_f32 v52, v52, v53
    v_mov_b32 v53, v52
    s_nop 1
    v_permlane32_swap_b32 v52, v53
    v_add_f32 v52, v52, v53
    v_cvt_pk_bf16_f32 v52, v52, v52
    v_and_b32 v52, 0xffff0000, v52
    v_add_f32 v52, v52, v18
    v_cvt_pk_bf16_f32 v52, v52, v52
    s_mov_b64 exec, 0xffff
    global_store_short v59, v52, s[22:23]
    s_endpgm
L_gen:
    s_xor_b32 s3, s2, 255
    s_or_b32 s3, s3, s39
    s_cbranch_scc1 L_fin
    s_mov_b64 exec, 1
    v_mov_b32 v52, s54
    global_store_dword v3, v52, s[26:27] offset:0 sc1
    s_nop 0
L_fin:
L_done:
    s_endpgm
L_oslow:
    global_store_dwordx2 v40, v[50:51], s[26:27] sc1
    s_branch L_osback
L_pslow:
    global_store_dwordx4 v46, v[48:51], s[26:27] sc1
    s_nop 0
    s_branch L_psback
L_prep:
L_mx:
    ds_read_b128 v[28:31], v3 offset:5056
    ds_read_b32 v32, v3 offset:5072
    v_mov_b32 v33, 2143363909
    s_waitcnt lgkmcnt(0)
    v_cmp_eq_u32 vcc, v28, v33
    v_cmp_eq_u32 s[0:1], v29, v33
    s_nop 0
    s_or_b64 vcc, vcc, s[0:1]
    v_cmp_eq_u32 s[0:1], v30, v33
    s_nop 0
    s_or_b64 vcc, vcc, s[0:1]
    v_cmp_eq_u32 s[0:1], v31, v33
    s_nop 0
    s_or_b64 vcc, vcc, s[0:1]
    v_cmp_eq_u32 s[0:1], v32, v33
    s_nop 0
    s_or_b64 vcc, vcc, s[0:1]
    s_nop 1
    s_cbranch_scc0 L_mx2
    s_sub_u32 s48, s48, 1
    s_cbranch_scc0 L_mx
    s_mov_b32 s48, 0
L_mx2:
    s_cmp_ge_u32 s53, 16
    s_cbranch_scc1 L_mx3
    ds_read_b64_tr_b16 v[128:129], v47 offset:0
    ds_read_b64_tr_b16 v[130:131], v47 offset:128
    ds_read_b64_tr_b16 v[132:133], v47 offset:256
    ds_read_b64_tr_b16 v[134:135], v47 offset:384
    ds_read_b64_tr_b16 v[136:137], v47 offset:4096
    ds_read_b64_tr_b16 v[138:139], v47 offset:4224
    ds_read_b64_tr_b16 v[140:141], v47 offset:4352
    ds_read_b64_tr_b16 v[142:143], v47 offset:4480
    ds_read_b64_tr_b16 v[144:145], v47 offset:32
    ds_read_b64_tr_b16 v[146:147], v47 offset:160
    ds_read_b64_tr_b16 v[148:149], v47 offset:288
    ds_read_b64_tr_b16 v[150:151], v47 offset:416
    ds_read_b64_tr_b16 v[152:153], v47 offset:4128
    ds_read_b64_tr_b16 v[154:155], v47 offset:4256
    ds_read_b64_tr_b16 v[156:157], v47 offset:4384
    ds_read_b64_tr_b16 v[158:159], v47 offset:4512
L_mx3:
    v_max_f32 v28, v28, v29
    v_max3_f32 v28, v28, v30, v31
    v_sub_f32 v29, v17, v28
    v_mul_f32 v29, 0x3fb8aa3b, v29
    v_exp_f32 v29, v29
    v_mov_b32 v17, v28
    v_mul_f32 v16, v16, v29
    v_mul_f32 v12, v12, v29
    v_mul_f32 v13, v13, v29
    v_mul_f32 v14, v14, v29
    v_mul_f32 v15, v15, v29
    s_nop 0
    s_branch L_vloop2
L_cpk:
    s_add_u32 s47, s47, 1
    s_cmp_eq_u32 s47, 2
    s_cbranch_scc1 L_cp1k
    s_cmp_eq_u32 s47, 3
    s_cbranch_scc1 L_cp2k
    v_mov_b32 v50, s4
    s_mov_b64 exec, s[44:45]
    s_cbranch_execz L_np17
    global_store_dwordx2 v253, v[50:51], s[26:27] sc1
L_np17:
    s_mov_b64 exec, -1
    v_add_u32 v253, 128, v253
    s_nop 0
    s_branch L_cbk
L_cp1k:
    s_mov_b64 exec, 0xffff
    global_load_dwordx2 v[52:53], v252, s[26:27] sc1
    s_mov_b64 exec, -1
    v_add_u32 v252, 128, v252
    s_nop 0
    s_branch L_cbk
L_cp2k:
    s_mov_b32 s47, 0
    v_cmp_eq_u32 vcc, s36, v53
    v_subrev_u32 v52, s4, v52
    s_nop 0
    v_cndmask_b32 v52, 0, v52, vcc
    s_and_b32 s14, vcc_lo, 0xffff
    s_bcnt1_i32_b32 s14, s14
    s_cbranch_scc0 L_cbk
    v_cvt_f32_i32 v52, v52
    v_cvt_f32_u32 v54, s14
    v_rcp_f32 v54, v54
    v_add_f32_dpp v52, v52, v52 quad_perm:[1,0,3,2] row_mask:0xf bank_mask:0xf
    s_nop 1
    v_add_f32_dpp v52, v52, v52 quad_perm:[2,3,0,1] row_mask:0xf bank_mask:0xf
    s_nop 1
    v_add_f32_dpp v52, v52, v52 row_half_mirror row_mask:0xf bank_mask:0xf
    s_nop 1
    v_add_f32_dpp v52, v52, v52 row_mirror row_mask:0xf bank_mask:0xf
    v_mul_f32 v54, 0x41800000, v54
    v_mul_f32 v52, v52, v54
    v_cvt_i32_f32 v52, v52
    s_lshl_b32 s14, s4, 4
    s_sub_u32 s14, s14, s15
    s_add_u32 s14, s14, 5184
    v_readfirstlane_b32 s3, v52
    s_nop 0
    s_add_u32 s3, s3, s14
    s_or_b32 s3, s3, 1
    v_mov_b32 v52, s3
    ds_write_b32 v3, v52 offset:2404
    s_branch L_cbk
L_cpv:
    s_add_u32 s47, s47, 1
    s_cmp_eq_u32 s47, 2
    s_cbranch_scc1 L_cp1v
    s_cmp_eq_u32 s47, 3
    s_cbranch_scc1 L_cp2v
    v_mov_b32 v50, s4
    s_mov_b64 exec, s[44:45]
    s_cbranch_execz L_np18
    global_store_dwordx2 v253, v[50:51], s[26:27] sc1
L_np18:
    s_mov_b64 exec, -1
    v_add_u32 v253, 128, v253
    s_nop 0
    s_branch L_cbv
L_cp1v:
    s_mov_b64 exec, 0xffff
    global_load_dwordx2 v[52:53], v252, s[26:27] sc1
    s_mov_b64 exec, -1
    v_add_u32 v252, 128, v252
    s_nop 0
    s_branch L_cbv
L_cp2v:
    s_mov_b32 s47, 0
    v_cmp_eq_u32 vcc, s36, v53
    v_subrev_u32 v52, s4, v52
    s_nop 0
    v_cndmask_b32 v52, 0, v52, vcc
    s_and_b32 s14, vcc_lo, 0xffff
    s_bcnt1_i32_b32 s14, s14
    s_cbranch_scc0 L_cbv
    v_cvt_f32_i32 v52, v52
    v_cvt_f32_u32 v54, s14
    v_rcp_f32 v54, v54
    v_add_f32_dpp v52, v52, v52 quad_perm:[1,0,3,2] row_mask:0xf bank_mask:0xf
    s_nop 1
    v_add_f32_dpp v52, v52, v52 quad_perm:[2,3,0,1] row_mask:0xf bank_mask:0xf
    s_nop 1
    v_add_f32_dpp v52, v52, v52 row_half_mirror row_mask:0xf bank_mask:0xf
    s_nop 1
    v_add_f32_dpp v52, v52, v52 row_mirror row_mask:0xf bank_mask:0xf
    v_mul_f32 v54, 0x41800000, v54
    v_mul_f32 v52, v52, v54
    v_cvt_i32_f32 v52, v52
    s_lshl_b32 s14, s4, 4
    s_sub_u32 s14, s14, s15
    s_add_u32 s14, s14, 5136
    v_readfirstlane_b32 s3, v52
    s_nop 0
    s_add_u32 s3, s3, s14
    s_or_b32 s3, s3, 1
    v_mov_b32 v52, s3
    ds_write_b32 v3, v52 offset:2404
    s_branch L_cbv
L_svc:
    v_lshrrev_b32 v41, 4, v1
    v_and_b32 v42, 15, v1
    v_lshl_add_u32 v43, v42, 2, v41
    s_lshl_b32 s3, s38, 6
    v_add_lshl_u32 v43, v43, s3, 1
    v_lshlrev_b32 v58, 13, v41
    v_lshl_add_u32 v58, v42, 4, v58
    s_mov_b32 s46, 4194304
    s_mov_b32 s47, 0x20000
    s_lshl_b32 s3, s38, 19
    s_lshl_b32 s14, s37, 8
    s_add_u32 s3, s3, s14
    s_waitcnt lgkmcnt(0)
    s_load_dword s54, s[26:27], 0
    global_load_dwordx4 v[36:39], v2, s[4:5]
    global_load_ushort v40, v43, s[4:5]
    s_mov_b32 s44, s10
    s_mov_b32 s45, s11
    buffer_load_dwordx4 v[64:67], v58, s[44:47], s3 offen nt
    s_add_u32 s3, s3, 0x8000
    buffer_load_dwordx4 v[68:71], v58, s[44:47], s3 offen nt
    s_add_u32 s3, s3, 0x8000
    buffer_load_dwordx4 v[72:75], v58, s[44:47], s3 offen nt
    s_add_u32 s3, s3, 0x8000
    buffer_load_dwordx4 v[76:79], v58, s[44:47], s3 offen nt
    s_add_u32 s3, s3, 0x8000
    buffer_load_dwordx4 v[80:83], v58, s[44:47], s3 offen nt
    s_add_u32 s3, s3, 0x8000
    buffer_load_dwordx4 v[84:87], v58, s[44:47], s3 offen nt
    s_add_u32 s3, s3, 0x8000
    buffer_load_dwordx4 v[88:91], v58, s[44:47], s3 offen nt
    s_add_u32 s3, s3, 0x8000
    buffer_load_dwordx4 v[92:95], v58, s[44:47], s3 offen nt
    s_add_u32 s3, s3, 0x8000
    buffer_load_dwordx4 v[96:99], v58, s[44:47], s3 offen nt
    s_add_u32 s3, s3, 0x8000
    buffer_load_dwordx4 v[100:103], v58, s[44:47], s3 offen nt
    s_add_u32 s3, s3, 0x8000
    buffer_load_dwordx4 v[104:107], v58, s[44:47], s3 offen nt
    s_add_u32 s3, s3, 0x8000
    buffer_load_dwordx4 v[108:111], v58, s[44:47], s3 offen nt
    s_add_u32 s3, s3, 0x8000
    buffer_load_dwordx4 v[112:115], v58, s[44:47], s3 offen nt
    s_add_u32 s3, s3, 0x8000
    buffer_load_dwordx4 v[116:119], v58, s[44:47], s3 offen nt
    s_add_u32 s3, s3, 0x8000
    buffer_load_dwordx4 v[120:123], v58, s[44:47], s3 offen nt
    s_add_u32 s3, s3, 0x8000
    buffer_load_dwordx4 v[124:127], v58, s[44:47], s3 offen nt
    s_and_b32 s55, s2, 7
    s_lshr_b32 s53, s2, 3
    s_and_b32 s49, s53, 15
    s_mov_b32 s48, 200000
    v_and_b32 v56, 1, v1
    v_lshlrev_b32 v56, 4, v56
    v_mov_b32 v57, 0xffff
    v_lshlrev_b32 v56, v56, v57
    v_bfe_u32 v57, v1, 1, 2
    v_cmp_eq_u32 vcc, 0, v57
    s_nop 1
    v_cndmask_b32 v4, 0, v56, vcc
    v_cmp_eq_u32 vcc, 1, v57
    s_nop 1
    v_cndmask_b32 v5, 0, v56, vcc
    v_cmp_eq_u32 vcc, 2, v57
    s_nop 1
    v_cndmask_b32 v6, 0, v56, vcc
    v_cmp_eq_u32 vcc, 3, v57
    s_nop 1
    v_cndmask_b32 v7, 0, v56, vcc
    s_lshl_b32 s3, s37, 3
    s_add_u32 s3, s3, s38
    s_lshl_b32 s3, s3, 10
    s_add_u32 s3, s3, 65536
    v_lshlrev_b32 v58, 6, v42
    v_lshl_add_u32 v58, v41, 5, v58
    v_add_u32 v58, s3, v58
    s_lshl_b32 s3, s37, 13
    s_add_u32 s3, s3, 69632
    v_add_u32 v59, s3, v2
    s_getreg_b32 s40, hwreg(HW_REG_XCC_ID, 0, 4)
    s_lshl_b32 s3, s55, 12
    s_add_u32 s3, s3, 557056
    v_and_b32 v61, 31, v1
    v_lshl_add_u32 v61, v61, 7, s3
    s_lshl_b32 s14, s53, 7
    s_add_u32 s3, s3, s14
    v_mov_b32 v60, s3
    s_waitcnt lgkmcnt(0)
    s_mul_i32 s54, s54, 1664525
    s_add_u32 s54, s54, 1013904223
    s_or_b32 s36, s54, 0x20000000
    v_mov_b32 v62, s40
    v_mov_b32 v63, s36
    s_mov_b64 exec, 1
    global_store_dwordx2 v60, v[62:63], s[26:27] sc1
    s_mov_b64 exec, -1
    s_waitcnt vmcnt(17)
    v_lshlrev_b32 v44, 16, v36
    v_and_b32 v45, 0xffff0000, v36
    v_lshlrev_b32 v46, 16, v37
    v_and_b32 v47, 0xffff0000, v37
    v_lshlrev_b32 v48, 16, v38
    v_and_b32 v49, 0xffff0000, v38
    v_lshlrev_b32 v50, 16, v39
    v_and_b32 v51, 0xffff0000, v39
    v_add_f32 v52, v44, v45
    v_add_f32 v52, v52, v46
    v_add_f32 v52, v52, v47
    v_add_f32 v52, v52, v48
    v_add_f32 v52, v52, v49
    v_add_f32 v52, v52, v50
    v_add_f32 v52, v52, v51
    s_nop 1
    v_add_f32_dpp v52, v52, v52 quad_perm:[1,0,3,2] row_mask:0xf bank_mask:0xf
    s_nop 1
    v_add_f32_dpp v52, v52, v52 quad_perm:[2,3,0,1] row_mask:0xf bank_mask:0xf
    s_nop 1
    v_add_f32_dpp v52, v52, v52 row_half_mirror row_mask:0xf bank_mask:0xf
    s_nop 1
    v_add_f32_dpp v52, v52, v52 row_mirror row_mask:0xf bank_mask:0xf
    s_nop 1
    v_add_f32_dpp v52, v52, v52 row_bcast:15 row_mask:0xa bank_mask:0xf
    s_nop 1
    v_add_f32_dpp v52, v52, v52 row_bcast:31 row_mask:0xc bank_mask:0xf
    v_mul_f32 v52, 0x3b000000, v52
    s_nop 0
    v_readlane_b32 s14, v52, 63
    s_nop 1
    v_subrev_f32 v44, s14, v44
    v_subrev_f32 v45, s14, v45
    v_subrev_f32 v46, s14, v46
    v_subrev_f32 v47, s14, v47
    v_subrev_f32 v48, s14, v48
    v_subrev_f32 v49, s14, v49
    v_subrev_f32 v50, s14, v50
    v_subrev_f32 v51, s14, v51
    v_cvt_pk_bf16_f32 v52, v52, v52
    v_and_b32 v52, 0xffff0000, v52
    v_mul_f32 v44, v44, v44
    v_readlane_b32 s14, v52, 63
    v_fmac_f32 v44, v45, v45
    v_fmac_f32 v44, v46, v46
    v_fmac_f32 v44, v47, v47
    v_fmac_f32 v44, v48, v48
    v_fmac_f32 v44, v49, v49
    v_fmac_f32 v44, v50, v50
    v_fmac_f32 v44, v51, v51
    s_nop 1
    v_add_f32_dpp v44, v44, v44 quad_perm:[1,0,3,2] row_mask:0xf bank_mask:0xf
    s_nop 1
    v_add_f32_dpp v44, v44, v44 quad_perm:[2,3,0,1] row_mask:0xf bank_mask:0xf
    s_nop 1
    v_add_f32_dpp v44, v44, v44 row_half_mirror row_mask:0xf bank_mask:0xf
    s_nop 1
    v_add_f32_dpp v44, v44, v44 row_mirror row_mask:0xf bank_mask:0xf
    s_nop 1
    v_add_f32_dpp v44, v44, v44 row_bcast:15 row_mask:0xa bank_mask:0xf
    s_nop 1
    v_add_f32_dpp v44, v44, v44 row_bcast:31 row_mask:0xc bank_mask:0xf
    v_mul_f32 v44, 0x3b000000, v44
    v_cvt_pk_bf16_f32 v44, v44, v44
    v_and_b32 v44, 0xffff0000, v44
    v_add_f32 v44, 0x3727c5ac, v44
    v_cvt_pk_bf16_f32 v44, v44, v44
    v_and_b32 v44, 0xffff0000, v44
    v_sqrt_f32 v44, v44
    s_nop 0
    v_cvt_pk_bf16_f32 v44, v44, v44
    v_and_b32 v44, 0xffff0000, v44
    v_rcp_f32 v45, v44
    v_readlane_b32 s15, v44, 63
    v_readlane_b32 s3, v45, 63
    v_lshlrev_b32 v40, 16, v40
    v_subrev_f32 v40, s14, v40
    v_cvt_pk_bf16_f32 v40, v40, v40
    v_and_b32 v40, 0xffff0000, v40
    v_mul_f32 v44, s3, v40
    v_fma_f32 v45, -v44, s15, v40
    v_fmac_f32 v44, s3, v45
    v_cvt_pk_bf16_f32 v40, v44, v44
    v_mov_b32 v37, 0
    s_mov_b32 s52, 2
    v_mov_b32 v49, s36
    v_mov_b32 v51, s36
    v_mov_b32 v53, s36
    v_mov_b32 v55, s36
    v_and_b32_dpp v28, v40, v4 row_newbcast:0 row_mask:0xf bank_mask:0xf
    v_and_b32_dpp v29, v40, v5 row_newbcast:0 row_mask:0xf bank_mask:0xf
    v_and_b32_dpp v30, v40, v6 row_newbcast:0 row_mask:0xf bank_mask:0xf
    v_and_b32_dpp v31, v40, v7 row_newbcast:0 row_mask:0xf bank_mask:0xf
    s_waitcnt vmcnt(16)
    s_nop 0
    v_mfma_f32_16x16x32_bf16 v[44:47], v[28:31], v[64:67], 0
    v_and_b32_dpp v32, v40, v4 row_newbcast:1 row_mask:0xf bank_mask:0xf
    v_and_b32_dpp v33, v40, v5 row_newbcast:1 row_mask:0xf bank_mask:0xf
    v_and_b32_dpp v34, v40, v6 row_newbcast:1 row_mask:0xf bank_mask:0xf
    v_and_b32_dpp v35, v40, v7 row_newbcast:1 row_mask:0xf bank_mask:0xf
    s_waitcnt vmcnt(15)
    s_nop 0
    v_mfma_f32_16x16x32_bf16 v[44:47], v[32:35], v[68:71], v[44:47]
    v_and_b32_dpp v28, v40, v4 row_newbcast:2 row_mask:0xf bank_mask:0xf
    v_and_b32_dpp v29, v40, v5 row_newbcast:2 row_mask:0xf bank_mask:0xf
    v_and_b32_dpp v30, v40, v6 row_newbcast:2 row_mask:0xf bank_mask:0xf
    v_and_b32_dpp v31, v40, v7 row_newbcast:2 row_mask:0xf bank_mask:0xf
    s_waitcnt vmcnt(14)
    s_nop 0
    v_mfma_f32_16x16x32_bf16 v[44:47], v[28:31], v[72:75], v[44:47]
    v_and_b32_dpp v32, v40, v4 row_newbcast:3 row_mask:0xf bank_mask:0xf
    v_and_b32_dpp v33, v40, v5 row_newbcast:3 row_mask:0xf bank_mask:0xf
    v_and_b32_dpp v34, v40, v6 row_newbcast:3 row_mask:0xf bank_mask:0xf
    v_and_b32_dpp v35, v40, v7 row_newbcast:3 row_mask:0xf bank_mask:0xf
    s_waitcnt vmcnt(13)
    s_nop 0
    v_mfma_f32_16x16x32_bf16 v[44:47], v[32:35], v[76:79], v[44:47]
    v_and_b32_dpp v28, v40, v4 row_newbcast:4 row_mask:0xf bank_mask:0xf
    v_and_b32_dpp v29, v40, v5 row_newbcast:4 row_mask:0xf bank_mask:0xf
    v_and_b32_dpp v30, v40, v6 row_newbcast:4 row_mask:0xf bank_mask:0xf
    v_and_b32_dpp v31, v40, v7 row_newbcast:4 row_mask:0xf bank_mask:0xf
    s_waitcnt vmcnt(12)
    s_nop 0
    v_mfma_f32_16x16x32_bf16 v[44:47], v[28:31], v[80:83], v[44:47]
    v_and_b32_dpp v32, v40, v4 row_newbcast:5 row_mask:0xf bank_mask:0xf
    v_and_b32_dpp v33, v40, v5 row_newbcast:5 row_mask:0xf bank_mask:0xf
    v_and_b32_dpp v34, v40, v6 row_newbcast:5 row_mask:0xf bank_mask:0xf
    v_and_b32_dpp v35, v40, v7 row_newbcast:5 row_mask:0xf bank_mask:0xf
    s_waitcnt vmcnt(11)
    s_nop 0
    v_mfma_f32_16x16x32_bf16 v[44:47], v[32:35], v[84:87], v[44:47]
    v_and_b32_dpp v28, v40, v4 row_newbcast:6 row_mask:0xf bank_mask:0xf
    v_and_b32_dpp v29, v40, v5 row_newbcast:6 row_mask:0xf bank_mask:0xf
    v_and_b32_dpp v30, v40, v6 row_newbcast:6 row_mask:0xf bank_mask:0xf
    v_and_b32_dpp v31, v40, v7 row_newbcast:6 row_mask:0xf bank_mask:0xf
    s_waitcnt vmcnt(10)
    s_nop 0
    v_mfma_f32_16x16x32_bf16 v[44:47], v[28:31], v[88:91], v[44:47]
    v_and_b32_dpp v32, v40, v4 row_newbcast:7 row_mask:0xf bank_mask:0xf
    v_and_b32_dpp v33, v40, v5 row_newbcast:7 row_mask:0xf bank_mask:0xf
    v_and_b32_dpp v34, v40, v6 row_newbcast:7 row_mask:0xf bank_mask:0xf
    v_and_b32_dpp v35, v40, v7 row_newbcast:7 row_mask:0xf bank_mask:0xf
    s_waitcnt vmcnt(9)
    s_nop 0
    v_mfma_f32_16x16x32_bf16 v[44:47], v[32:35], v[92:95], v[44:47]
    v_and_b32_dpp v28, v40, v4 row_newbcast:8 row_mask:0xf bank_mask:0xf
    v_and_b32_dpp v29, v40, v5 row_newbcast:8 row_mask:0xf bank_mask:0xf
    v_and_b32_dpp v30, v40, v6 row_newbcast:8 row_mask:0xf bank_mask:0xf
    v_and_b32_dpp v31, v40, v7 row_newbcast:8 row_mask:0xf bank_mask:0xf
    s_waitcnt vmcnt(8)
    s_nop 0
    v_mfma_f32_16x16x32_bf16 v[44:47], v[28:31], v[96:99], v[44:47]
    v_and_b32_dpp v32, v40, v4 row_newbcast:9 row_mask:0xf bank_mask:0xf
    v_and_b32_dpp v33, v40, v5 row_newbcast:9 row_mask:0xf bank_mask:0xf
    v_and_b32_dpp v34, v40, v6 row_newbcast:9 row_mask:0xf bank_mask:0xf
    v_and_b32_dpp v35, v40, v7 row_newbcast:9 row_mask:0xf bank_mask:0xf
    s_waitcnt vmcnt(7)
    s_nop 0
    v_mfma_f32_16x16x32_bf16 v[44:47], v[32:35], v[100:103], v[44:47]
    v_and_b32_dpp v28, v40, v4 row_newbcast:10 row_mask:0xf bank_mask:0xf
    v_and_b32_dpp v29, v40, v5 row_newbcast:10 row_mask:0xf bank_mask:0xf
    v_and_b32_dpp v30, v40, v6 row_newbcast:10 row_mask:0xf bank_mask:0xf
    v_and_b32_dpp v31, v40, v7 row_newbcast:10 row_mask:0xf bank_mask:0xf
    s_waitcnt vmcnt(6)
    s_nop 0
    v_mfma_f32_16x16x32_bf16 v[44:47], v[28:31], v[104:107], v[44:47]
    v_and_b32_dpp v32, v40, v4 row_newbcast:11 row_mask:0xf bank_mask:0xf
    v_and_b32_dpp v33, v40, v5 row_newbcast:11 row_mask:0xf bank_mask:0xf
    v_and_b32_dpp v34, v40, v6 row_newbcast:11 row_mask:0xf bank_mask:0xf
    v_and_b32_dpp v35, v40, v7 row_newbcast:11 row_mask:0xf bank_mask:0xf
    s_waitcnt vmcnt(5)
    s_nop 0
    v_mfma_f32_16x16x32_bf16 v[44:47], v[32:35], v[108:111], v[44:47]
    v_and_b32_dpp v28, v40, v4 row_newbcast:12 row_mask:0xf bank_mask:0xf
    v_and_b32_dpp v29, v40, v5 row_newbcast:12 row_mask:0xf bank_mask:0xf
    v_and_b32_dpp v30, v40, v6 row_newbcast:12 row_mask:0xf bank_mask:0xf
    v_and_b32_dpp v31, v40, v7 row_newbcast:12 row_mask:0xf bank_mask:0xf
    s_waitcnt vmcnt(4)
    s_nop 0
    v_mfma_f32_16x16x32_bf16 v[44:47], v[28:31], v[112:115], v[44:47]
    v_and_b32_dpp v32, v40, v4 row_newbcast:13 row_mask:0xf bank_mask:0xf
    v_and_b32_dpp v33, v40, v5 row_newbcast:13 row_mask:0xf bank_mask:0xf
    v_and_b32_dpp v34, v40, v6 row_newbcast:13 row_mask:0xf bank_mask:0xf
    v_and_b32_dpp v35, v40, v7 row_newbcast:13 row_mask:0xf bank_mask:0xf
    s_waitcnt vmcnt(3)
    s_nop 0
    v_mfma_f32_16x16x32_bf16 v[44:47], v[32:35], v[116:119], v[44:47]
    v_and_b32_dpp v28, v40, v4 row_newbcast:14 row_mask:0xf bank_mask:0xf
    v_and_b32_dpp v29, v40, v5 row_newbcast:14 row_mask:0xf bank_mask:0xf
    v_and_b32_dpp v30, v40, v6 row_newbcast:14 row_mask:0xf bank_mask:0xf
    v_and_b32_dpp v31, v40, v7 row_newbcast:14 row_mask:0xf bank_mask:0xf
    s_waitcnt vmcnt(2)
    s_nop 0
    v_mfma_f32_16x16x32_bf16 v[44:47], v[28:31], v[120:123], v[44:47]
    v_and_b32_dpp v32, v40, v4 row_newbcast:15 row_mask:0xf bank_mask:0xf
    v_and_b32_dpp v33, v40, v5 row_newbcast:15 row_mask:0xf bank_mask:0xf
    v_and_b32_dpp v34, v40, v6 row_newbcast:15 row_mask:0xf bank_mask:0xf
    v_and_b32_dpp v35, v40, v7 row_newbcast:15 row_mask:0xf bank_mask:0xf
    s_waitcnt vmcnt(1)
    s_nop 0
    v_mfma_f32_16x16x32_bf16 v[44:47], v[32:35], v[124:127], v[44:47]
    s_nop 7
    v_mov_b32 v48, v44
    v_mov_b32 v50, v45
    v_mov_b32 v52, v46
    v_mov_b32 v54, v47
    s_mov_b32 exec_hi, 0
    global_store_dwordx4 v58, v[48:51], s[26:27]
    global_store_dwordx4 v58, v[52:55], s[26:27] offset:16
    s_mov_b64 exec, -1
    global_load_dwordx4 v[64:67], v59, s[26:27] offset:-4096 sc1
    global_load_dwordx4 v[68:71], v59, s[26:27] offset:-3072 sc1
    global_load_dwordx4 v[72:75], v59, s[26:27] offset:-2048 sc1
    global_load_dwordx4 v[76:79], v59, s[26:27] offset:-1024 sc1
    global_load_dwordx4 v[80:83], v59, s[26:27] offset:0 sc1
    global_load_dwordx4 v[84:87], v59, s[26:27] offset:1024 sc1
    global_load_dwordx4 v[88:91], v59, s[26:27] offset:2048 sc1
    global_load_dwordx4 v[92:95], v59, s[26:27] offset:3072 sc1
L_q_chk:
    s_waitcnt vmcnt(0)
    s_cmp_lg_u32 s52, 2
    s_cbranch_scc1 L_q_c2
    v_cmp_ne_u32 vcc, s36, v37
    s_cbranch_vccz L_q_mode
    global_load_dwordx2 v[36:37], v61, s[26:27] sc1
    s_branch L_q_c2
L_q_mode:
    v_cmp_ne_u32 vcc, s40, v36
    s_nop 0
    s_cmp_eq_u64 vcc, 0
    s_cselect_b32 s52, 1, 0
    s_cmp_eq_u32 s52, 1
    s_cbranch_scc1 L_q_c2
    s_mov_b32 exec_hi, 0
    global_store_dwordx4 v58, v[48:51], s[26:27] sc1
    global_store_dwordx4 v58, v[52:55], s[26:27] offset:16 sc1
    s_mov_b64 exec, -1
    s_nop 0
L_q_c2:
    v_xor_b32 v44, s36, v65
    v_bitop3_b32 v44, v44, s36, v67 bitop3:0xf6
    v_bitop3_b32 v44, v44, s36, v69 bitop3:0xf6
    v_bitop3_b32 v44, v44, s36, v71 bitop3:0xf6
    v_bitop3_b32 v44, v44, s36, v73 bitop3:0xf6
    v_bitop3_b32 v44, v44, s36, v75 bitop3:0xf6
    v_bitop3_b32 v44, v44, s36, v77 bitop3:0xf6
    v_bitop3_b32 v44, v44, s36, v79 bitop3:0xf6
    v_bitop3_b32 v44, v44, s36, v81 bitop3:0xf6
    v_bitop3_b32 v44, v44, s36, v83 bitop3:0xf6
    v_bitop3_b32 v44, v44, s36, v85 bitop3:0xf6
    v_bitop3_b32 v44, v44, s36, v87 bitop3:0xf6
    v_bitop3_b32 v44, v44, s36, v89 bitop3:0xf6
    v_bitop3_b32 v44, v44, s36, v91 bitop3:0xf6
    v_bitop3_b32 v44, v44, s36, v93 bitop3:0xf6
    v_bitop3_b32 v44, v44, s36, v95 bitop3:0xf6
    v_cmp_ne_u32 vcc, 0, v44
    s_cbranch_vccnz L_q_re
    s_cmp_lg_u32 s52, 2
    s_cbranch_scc1 L_q_got
    s_branch L_q_nx
L_q_re:
    s_mov_b64 exec, vcc
    global_load_dwordx4 v[64:67], v59, s[26:27] offset:-4096 sc1
    global_load_dwordx4 v[68:71], v59, s[26:27] offset:-3072 sc1
    global_load_dwordx4 v[72:75], v59, s[26:27] offset:-2048 sc1
    global_load_dwordx4 v[76:79], v59, s[26:27] offset:-1024 sc1
    global_load_dwordx4 v[80:83], v59, s[26:27] offset:0 sc1
    global_load_dwordx4 v[84:87], v59, s[26:27] offset:1024 sc1
    global_load_dwordx4 v[88:91], v59, s[26:27] offset:2048 sc1
    global_load_dwordx4 v[92:95], v59, s[26:27] offset:3072 sc1
    s_mov_b64 exec, -1
L_q_nx:
    s_sub_u32 s48, s48, 1
    s_cbranch_scc0 L_q_chk
    s_mov_b32 s48, 0
    s_waitcnt vmcnt(0)
L_q_got:
    v_add_f32 v64, v64, v68
    v_add_f32 v66, v66, v70
    v_add_f32 v64, v64, v72
    v_add_f32 v66, v66, v74
    v_add_f32 v64, v64, v76
    v_add_f32 v66, v66, v78
    v_add_f32 v64, v64, v80
    v_add_f32 v66, v66, v82
    v_add_f32 v64, v64, v84
    v_add_f32 v66, v66, v86
    v_add_f32 v64, v64, v88
    v_add_f32 v66, v66, v90
    v_add_f32 v64, v64, v92
    v_add_f32 v66, v66, v94
    v_cvt_pk_bf16_f32 v44, v64, v66
    v_lshlrev_b32 v43, 2, v1
    ds_write_b32 v43, v44 offset:0
    v_mov_b32 v36, s52
    v_mov_b32 v37, 0
    ds_write_b64 v37, v[36:37] offset:2400
    v_mov_b32 v38, 2143363909
    s_cmp_lt_u32 s53, 16
    s_cselect_b64 exec, 31, 15
    ds_write_b32 v37, v37 offset:5072
    ds_write_b32 v43, v38 offset:5056
    s_mov_b64 exec, -1
    s_lshl_b32 s3, s55, 9
    s_add_u32 s3, s3, s53
    s_lshl_b32 s3, s3, 10
    v_add_u32 v53, s3, v2
    s_lshl_b32 s14, s55, 16
    s_mov_b32 s15, 16
L_warm:
    s_and_b32 s3, s14, 0x78000
    v_add_u32 v52, s3, v53
    s_add_u32 s14, s14, 0x8000
    s_waitcnt vmcnt(15)
    global_load_dwordx4 v[64:67], v52, s[12:13]
    s_sub_u32 s15, s15, 1
    s_cmp_lg_u32 s15, 0
    s_cbranch_scc1 L_warm
    s_waitcnt lgkmcnt(0)
    s_barrier
    s_cmp_lt_u32 s53, 16
    s_cbranch_scc1 L_svcA
    s_mul_i32 s3, s55, 14
    s_add_u32 s3, s3, s49
    s_mul_i32 s3, s3, 4224
    s_add_u32 s3, s3, 655360
    s_lshl_b32 s14, s55, 11
    s_add_u32 s14, s14, 589824
    s_cmp_lt_u32 s49, 14
    s_cselect_b32 s3, s3, s14
    s_cselect_b32 s6, -1, 0xffff
    v_lshl_add_u32 v52, v1, 7, s3
    s_lshl_b32 s3, s49, 11
    s_add_u32 s3, s3, 487424
    s_mov_b32 exec_lo, 0
    v_lshl_add_u32 v52, v1, 7, s3
    s_mov_b32 exec_lo, s6
    s_mov_b32 exec_hi, 0
    global_load_dword v64, v52, s[26:27] sc1
    s_mul_i32 s3, s37, 4224
    s_add_u32 s3, s3, 327680
    s_mov_b64 exec, -1
    v_lshl_add_u32 v52, v1, 7, s3
    s_cmp_lg_u32 s38, 4
    s_cbranch_scc1 L_svcB2
    s_mov_b32 exec_hi, 1
    global_load_dword v65, v52, s[26:27] sc1
L_svcB2:
    s_and_b32 s3, s49, 7
    s_cmp_lg_u32 s3, s55
    s_cbranch_scc1 L_done
    s_mov_b64 exec, 1
    s_endpgm
L_svcA:
    v_lshrrev_b32 v52, 2, v1
    v_lshlrev_b32 v52, 10, v52
    v_and_b32 v53, 3, v1
    v_lshl_add_u32 v52, v53, 4, v52
    s_lshl_b32 s3, s55, 19
    s_lshl_b32 s14, s49, 6
    s_add_u32 s3, s3, s14
    v_add_u32 v52, s3, v52
    s_mov_b32 m0, 21504
    s_nop 0
L_swait:
    s_sleep 8
    ds_read_b32 v39, v37 offset:5056
    s_waitcnt lgkmcnt(0)
    v_cmp_ne_u32 vcc, v38, v39
    s_cbranch_vccnz L_swo
    s_sub_u32 s48, s48, 1
    s_cbranch_scc0 L_swait
L_swo:
    s_waitcnt vmcnt(2)
    global_load_lds_dwordx4 v52, s[12:13]
    v_add_u32 v52, 0x4000, v52
    s_add_u32 m0, m0, 1024
    s_cmp_lt_u32 m0, 54272
    s_cbranch_scc1 L_swo
    s_waitcnt vmcnt(0)
    ds_write_b32 v37, v37 offset:5072
    s_waitcnt lgkmcnt(0)
    s_endpgm
L_codeend:
.section .rodata,"a"
.p2align 6
.amdhsa_kernel sequential_preLN__mha_block_cached__swiglu_ffn__decode_kernel
  .amdhsa_next_free_vgpr 256
  .amdhsa_next_free_sgpr 102
  .amdhsa_accum_offset 256
  .amdhsa_group_segment_fixed_size 0
  .amdhsa_kernarg_size 96
  .amdhsa_user_sgpr_count 2
  .amdhsa_user_sgpr_kernarg_segment_ptr 1
  .amdhsa_system_sgpr_workgroup_id_x 1
  .amdhsa_float_denorm_mode_32 3
.end_amdhsa_kernel
```
